```python
import torch

def _softmax(x, axis=-1):
    return torch.softmax(x, dim=axis)
def _gelu(x):
    return torch.nn.functional.gelu(x, approximate="tanh")
def _silu(x):
    return torch.nn.functional.silu(x)
def _sigmoid(x):
    return torch.sigmoid(x)
def _layernorm(x, axis=-1, eps=1e-5):
    m = x.mean(dim=axis, keepdim=True)
    v = x.var(dim=axis, keepdim=True, unbiased=False)
    return (x - m) / torch.sqrt(v + eps)
def _scatter_add(tgt, idx, src, axis=0):
    return tgt.clone().index_add_(axis, idx, src)
def _segment_sum(src, seg, n):
    out = torch.zeros((n,) + src.shape[1:], dtype=src.dtype)
    return out.index_add_(0, seg, src)
def _pad(x, pw):
    flat = tuple(v for pair in reversed(pw) for v in pair)
    return torch.nn.functional.pad(x, flat)

kernel_name = 'gated_mix__mha_block_cached__geglu_ffn__decode'

def setup_inputs():

    _w = (lambda a: (lambda t: t.to(torch.bfloat16) if t.is_floating_point() else t)(torch.as_tensor(a)))
    def _A_setup():
        B, Sq, D = 4, 1, 640
        H, Sk, Dh = 32, 4096, 192
        return {
            "x": _w((lambda *s: torch.randn(*s, dtype=torch.bfloat16) * 0.05)(B, Sq, D)),
            "k_cache": _w((lambda *s: torch.randn(*s, dtype=torch.bfloat16) * 6.4)(B, H, Sk, Dh)),
            "v_cache": _w((lambda *s: torch.randn(*s, dtype=torch.bfloat16) * 0.2)(B, H, Sk, Dh)),
            "wq": _w((lambda *s: torch.randn(*s, dtype=torch.bfloat16) * 6.4)(D, H * Dh) * (D ** -0.5)),
            "wo": _w((lambda *s: torch.randn(*s, dtype=torch.bfloat16) * 0.2)(H * Dh, D) * ((H * Dh) ** -0.5)),
        }
    _A_in = _A_setup()

    def _B_setup():
        B, S, D, F = 4, 1, 640, 1536
        return {
            "x": _w((lambda *s: torch.randn(*s, dtype=torch.bfloat16) * 0.05)(B, S, D)),
            "w_gate": _w((lambda *s: torch.randn(*s, dtype=torch.bfloat16) * 0.05)(D, F)),
            "w_up": _w((lambda *s: torch.randn(*s, dtype=torch.bfloat16) * 0.05)(D, F)),
            "w_down": _w((lambda *s: torch.randn(*s, dtype=torch.bfloat16) * 0.05)(F, D)),
        }
    _B_in = _B_setup()

    return {
        "A_x": _A_in["x"],
        "A_k_cache": _A_in["k_cache"],
        "A_v_cache": _A_in["v_cache"],
        "A_wq": _A_in["wq"],
        "A_wo": _A_in["wo"],
        "B_x": _B_in["x"],
        "B_w_gate": _B_in["w_gate"],
        "B_w_up": _B_in["w_up"],
        "B_w_down": _B_in["w_down"],
        "gate_w": _w((lambda *s: torch.randn(*s, dtype=torch.bfloat16) * 0.05)(640) * 16.0),
    }

def reference(A_x, A_k_cache, A_v_cache, A_wq, A_wo, B_x, B_w_gate, B_w_up, B_w_down, gate_w):
    def _A_ref(x, k_cache, v_cache, wq, wo):
        B, Sq, D = x.shape
        H, Dh = 32, 192
        q = (lambda x, *d: x.permute(*d))((x @ wq).reshape(B, Sq, H, Dh), 0, 2, 1, 3)
        scores = torch.einsum("bhqd,bhkd->bhqk", q, k_cache) * (Dh ** -0.5)
        p = _softmax(scores, axis=-1)
        o = torch.einsum("bhqk,bhkd->bhqd", p, v_cache)
        return (lambda x, *d: x.permute(*d))(o, 0, 2, 1, 3).reshape(B, Sq, H * Dh) @ wo

    def _B_ref(x, w_gate, w_up, w_down):
        return (_gelu(x @ w_gate) * (x @ w_up)) @ w_down

    x = A_x
    g = _sigmoid((x * gate_w).sum(-1, keepdims=True))
    a = _A_ref(x, A_k_cache, A_v_cache, A_wq, A_wo)
    b = _B_ref(x, B_w_gate, B_w_up, B_w_down)
    return g * a + (1 - g) * b
```

```asm
; @launch grid=(256,1,1) block=(384,1,1) lds=98304
.amdgcn_target "amdgcn-amd-amdhsa--gfx950"
.text
.globl gated_mix__mha_block_cached__geglu_ffn__decode_kernel
.p2align 8
.type gated_mix__mha_block_cached__geglu_ffn__decode_kernel,@function
gated_mix__mha_block_cached__geglu_ffn__decode_kernel:
  s_cmp_ge_u32 s2, 256
  s_cbranch_scc1 L_end
  s_load_dwordx8 s[4:11], s[0:1], 0
  v_lshrrev_b32 v1, 6, v0
  s_lshr_b32 s78, s2, 3
  v_and_b32 v2, 63, v0
  v_readfirstlane_b32 s30, v1
  s_and_b32 s3, s2, 7
  s_mul_i32 s56, s78, 52429
  s_lshr_b32 s56, s56, 18
  s_mul_i32 s57, s56, 5
  s_sub_u32 s57, s78, s57
  s_cmp_ge_u32 s30, 4
  s_cbranch_scc1 L_aux
  s_lshl_b32 s48, s57, 2
  s_add_u32 s48, s48, s30
  s_mul_i32 s49, s48, 393216
  s_mul_i32 s50, s3, 6
  s_add_u32 s50, s50, s56
  s_lshl_b32 s50, s50, 8
  s_add_u32 s49, s49, s50
  v_lshrrev_b32 v52, 4, v2
  v_mul_u32_u24 v53, 0x18000, v52
  v_and_b32 v7, 15, v2
  v_lshl_add_u32 v53, v7, 4, v53
  s_cmp_lt_u32 s78, 30
  s_cselect_b32 s62, 7864320, 0
  s_mov_b32 s63, 0x20000
  s_waitcnt lgkmcnt(0)
  s_mov_b32 s60, s10
  s_mov_b32 s61, s11
  buffer_load_dwordx4 v[208:211], v53, s[60:63], s49 offen nt
  s_addk_i32 s49, 12288
  buffer_load_dwordx4 v[212:215], v53, s[60:63], s49 offen nt
  s_addk_i32 s49, 12288
  buffer_load_dwordx4 v[216:219], v53, s[60:63], s49 offen nt
  s_addk_i32 s49, 12288
  buffer_load_dwordx4 v[220:223], v53, s[60:63], s49 offen nt
  s_addk_i32 s49, 12288
  buffer_load_dwordx4 v[224:227], v53, s[60:63], s49 offen nt
  s_addk_i32 s49, 12288
  buffer_load_dwordx4 v[228:231], v53, s[60:63], s49 offen nt
  s_addk_i32 s49, 12288
  buffer_load_dwordx4 v[232:235], v53, s[60:63], s49 offen nt
  s_addk_i32 s49, 12288
  buffer_load_dwordx4 v[236:239], v53, s[60:63], s49 offen nt
  s_load_dwordx2 s[12:13], s[0:1], 32
  s_load_dwordx2 s[24:25], s[0:1], 80
  s_load_dwordx2 s[28:29], s[0:1], 96
  v_and_b32 v54, 3, v2
  v_mul_u32_u24 v54, 1280, v54
  v_lshl_add_u32 v54, v52, 4, v54
  s_lshl_b32 s48, s48, 6
  s_mov_b32 s68, s4
  s_mov_b32 s69, s5
  s_mov_b32 s70, 5120
  s_mov_b32 s71, 0x20000
  buffer_load_dwordx4 v[240:243], v54, s[68:71], s48 offen
  s_and_b32 s40, s78, 3
  s_lshl_b32 s41, s3, 2
  s_add_u32 s40, s40, s41
  s_lshl_b32 s40, s40, 2
  s_mov_b32 s41, 0
  s_add_u32 s40, s40, s41
  s_mul_i32 s31, s40, 393216
  v_lshrrev_b32 v3, 3, v2
  v_mul_u32_u24 v3, 384, v3
  v_and_b32 v6, 7, v2
  v_lshlrev_b32 v6, 4, v6
  v_add_u32 v3, v3, v6
  s_mov_b32 s43, s30
  s_mul_i32 s41, s3, 12
  s_add_u32 s43, s43, s41
  s_and_b32 s41, s78, 3
  s_mul_i32 s41, s41, 3
  s_add_u32 s43, s43, s41
  s_add_u32 s32, s6, s31
  s_addc_u32 s33, s7, 0
  s_mov_b32 s34, 1572864
  s_mov_b32 s35, 0x20000
  s_lshr_b32 s41, s78, 2
  s_lshl_b32 s41, s41, 0
  v_bfe_u32 v52, v2, 0, 5
  v_and_or_b32 v60, v2, 0, s41
  v_lshl_add_u32 v60, v52, 3, v60
  v_and_b32 v55, 224, v60
  v_lshlrev_b32 v55, 1, v55
  v_and_b32 v60, 31, v60
  v_cmp_lt_u32 vcc, 10, v60
  v_cmp_lt_u32 s[46:47], 20, v60
  v_add_u32 v60, v60, v55
  v_cndmask_b32 v52, 0, 11, vcc
  v_cndmask_b32 v53, 0, 10, s[46:47]
  v_add3_u32 v60, v60, v52, v53
  s_andn2_b64 vcc, vcc, s[46:47]
  v_cndmask_b32 v52, 11, 10, vcc
  v_add_u32 v61, v60, v52
  v_mul_u32_u24 v60, 3072, v60
  v_mul_u32_u24 v61, 3072, v61
  v_readlane_b32 s44, v60, s43
  v_readlane_b32 s45, v61, s43
  s_add_u32 s43, s43, 4
  s_nop 2
  s_waitcnt vmcnt(8)
  buffer_load_dwordx4 v[64:67], v3, s[32:35], s44 offen offset:0 nt
  s_waitcnt vmcnt(8)
  buffer_load_dwordx4 v[68:71], v3, s[32:35], s45 offen offset:0 nt
  s_waitcnt vmcnt(8)
  buffer_load_dwordx4 v[72:75], v3, s[32:35], s44 offen offset:128 nt
  s_waitcnt vmcnt(8)
  buffer_load_dwordx4 v[76:79], v3, s[32:35], s45 offen offset:128 nt
  s_waitcnt vmcnt(8)
  buffer_load_dwordx4 v[80:83], v3, s[32:35], s44 offen offset:256 nt
  s_waitcnt vmcnt(8)
  buffer_load_dwordx4 v[84:87], v3, s[32:35], s45 offen offset:256 nt
  v_readlane_b32 s44, v60, s43
  v_readlane_b32 s45, v61, s43
  s_add_u32 s43, s43, 4
  s_nop 2
  s_waitcnt vmcnt(8)
  buffer_load_dwordx4 v[88:91], v3, s[32:35], s44 offen offset:0 nt
  s_waitcnt vmcnt(8)
  buffer_load_dwordx4 v[92:95], v3, s[32:35], s45 offen offset:0 nt
  s_mov_b32 s58, 0x05040100
  s_mov_b32 s59, 0x07060302
  s_movk_i32 s77, 0xff
  v_mul_u32_u24 v53, 144, v2
  s_mul_i32 s40, s30, 2304
  v_add_u32 v53, s40, v53
  v_mov_b32 v5, 0
  v_mov_b32 v55, 1
  s_waitcnt lgkmcnt(0)
  s_load_dword s55, s[28:29], 0
  s_barrier
  s_mov_b32 s64, s28
  s_mov_b32 s65, s29
  s_mov_b32 s66, 3821568
  s_mov_b32 s67, 0x20000
  s_waitcnt vmcnt(8)
  buffer_load_dwordx4 v[96:99], v3, s[32:35], s44 offen offset:128 nt
  v_perm_b32 v192, v212, v208, s58
  v_perm_b32 v193, v220, v216, s58
  v_perm_b32 v194, v228, v224, s58
  v_perm_b32 v195, v236, v232, s58
  buffer_load_dwordx4 v[100:103], v3, s[32:35], s45 offen offset:128 nt
  v_perm_b32 v196, v212, v208, s59
  v_perm_b32 v197, v220, v216, s59
  v_perm_b32 v198, v228, v224, s59
  v_perm_b32 v199, v236, v232, s59
  v_mfma_f32_16x16x32_bf16 v[160:163], v[240:243], v[192:195], 0
  buffer_load_dwordx4 v[104:107], v3, s[32:35], s44 offen offset:256 nt
  v_perm_b32 v192, v213, v209, s58
  v_perm_b32 v193, v221, v217, s58
  v_perm_b32 v194, v229, v225, s58
  v_perm_b32 v195, v237, v233, s58
  v_mfma_f32_16x16x32_bf16 v[164:167], v[240:243], v[196:199], 0
  buffer_load_dwordx4 v[108:111], v3, s[32:35], s45 offen offset:256 nt
  v_perm_b32 v196, v213, v209, s59
  v_perm_b32 v197, v221, v217, s59
  v_perm_b32 v198, v229, v225, s59
  v_perm_b32 v199, v237, v233, s59
  v_mfma_f32_16x16x32_bf16 v[168:171], v[240:243], v[192:195], 0
  v_perm_b32 v192, v214, v210, s58
  v_perm_b32 v193, v222, v218, s58
  v_perm_b32 v194, v230, v226, s58
  v_perm_b32 v195, v238, v234, s58
  v_mfma_f32_16x16x32_bf16 v[172:175], v[240:243], v[196:199], 0
  v_perm_b32 v196, v214, v210, s59
  v_perm_b32 v197, v222, v218, s59
  v_perm_b32 v198, v230, v226, s59
  v_perm_b32 v199, v238, v234, s59
  v_mfma_f32_16x16x32_bf16 v[176:179], v[240:243], v[192:195], 0
  v_perm_b32 v192, v215, v211, s58
  v_perm_b32 v193, v223, v219, s58
  v_perm_b32 v194, v231, v227, s58
  v_perm_b32 v195, v239, v235, s58
  v_mfma_f32_16x16x32_bf16 v[180:183], v[240:243], v[196:199], 0
  v_perm_b32 v196, v215, v211, s59
  v_perm_b32 v197, v223, v219, s59
  v_perm_b32 v198, v231, v227, s59
  v_perm_b32 v199, v239, v235, s59
  v_mfma_f32_16x16x32_bf16 v[184:187], v[240:243], v[192:195], 0
  s_nop 1
  v_mfma_f32_16x16x32_bf16 v[188:191], v[240:243], v[196:199], 0
  s_nop 0
  s_mov_b64 exec, 0xffff
  ds_write_b128 v53, v[160:163] offset:3072
  ds_write_b128 v53, v[164:167] offset:3088
  ds_write_b128 v53, v[168:171] offset:3104
  ds_write_b128 v53, v[172:175] offset:3120
  ds_write_b128 v53, v[176:179] offset:3136
  ds_write_b128 v53, v[180:183] offset:3152
  ds_write_b128 v53, v[184:187] offset:3168
  ds_write_b128 v53, v[188:191] offset:3184
  s_mov_b64 exec, 1
  ds_add_u32 v5, v55 offset:408
  s_mov_b64 exec, -1
  v_lshlrev_b32 v4, 3, v2
  s_lshl_b32 s40, s30, 9
  s_add_u32 s40, s40, 32768
  v_add_u32 v4, s40, v4
  v_lshlrev_b32 v57, 2, v2
  v_readlane_b32 s44, v60, s43
  v_readlane_b32 s45, v61, s43
  s_add_u32 s43, s43, 4
  s_nop 2
  s_waitcnt vmcnt(5)
  buffer_load_dwordx4 v[112:115], v3, s[32:35], s44 offen offset:0 nt
  s_waitcnt vmcnt(5)
  buffer_load_dwordx4 v[116:119], v3, s[32:35], s45 offen offset:0 nt
  s_waitcnt vmcnt(5)
  buffer_load_dwordx4 v[120:123], v3, s[32:35], s44 offen offset:128 nt
  s_waitcnt vmcnt(5)
  buffer_load_dwordx4 v[124:127], v3, s[32:35], s45 offen offset:128 nt
  s_waitcnt vmcnt(5)
  buffer_load_dwordx4 v[128:131], v3, s[32:35], s44 offen offset:256 nt
  s_waitcnt vmcnt(5)
  buffer_load_dwordx4 v[132:135], v3, s[32:35], s45 offen offset:256 nt
  v_mov_b32 v56, 192
  v_mov_b32 v58, 84
  v_and_b32 v7, 1, v2
  v_lshlrev_b32 v7, 4, v7
  v_mov_b32 v52, 0xffff
  v_lshlrev_b32 v7, v7, v52
  v_bfe_u32 v52, v2, 1, 2
  v_cmp_eq_u32 vcc, 0, v52
  s_nop 1
  v_cndmask_b32 v28, 0, v7, vcc
  v_cmp_eq_u32 vcc, 1, v52
  s_nop 1
  v_cndmask_b32 v29, 0, v7, vcc
  v_cmp_eq_u32 vcc, 2, v52
  s_nop 1
  v_cndmask_b32 v30, 0, v7, vcc
  v_cmp_eq_u32 vcc, 3, v52
  s_nop 1
  v_cndmask_b32 v31, 0, v7, vcc
  v_readlane_b32 s44, v60, s43
  v_readlane_b32 s45, v61, s43
  s_add_u32 s43, s43, 4
  s_nop 2
  s_waitcnt vmcnt(5)
  buffer_load_dwordx4 v[136:139], v3, s[32:35], s44 offen offset:0 nt
  s_waitcnt vmcnt(5)
  buffer_load_dwordx4 v[140:143], v3, s[32:35], s45 offen offset:0 nt
  s_waitcnt vmcnt(5)
  buffer_load_dwordx4 v[144:147], v3, s[32:35], s44 offen offset:128 nt
  s_waitcnt vmcnt(5)
  buffer_load_dwordx4 v[148:151], v3, s[32:35], s45 offen offset:128 nt
  s_waitcnt vmcnt(5)
  buffer_load_dwordx4 v[152:155], v3, s[32:35], s44 offen offset:256 nt
  s_waitcnt vmcnt(5)
  buffer_load_dwordx4 v[156:159], v3, s[32:35], s45 offen offset:256 nt
  v_lshrrev_b32 v52, 5, v2
  v_lshlrev_b32 v52, 11, v52
  v_and_b32 v53, 8, v2
  v_lshl_add_u32 v52, v53, 9, v52
  v_lshl_add_u32 v52, v6, 4, v52
  v_and_b32 v53, 16, v2
  v_lshl_add_u32 v59, v53, 3, v52
  v_mov_b32 v62, v6
  s_and_b32 s68, s78, 3
  s_lshl_b32 s40, s3, 2
  s_add_u32 s68, s68, s40
  s_mul_i32 s68, s68, 25088
  s_lshr_b32 s40, s78, 2
  s_lshl_b32 s40, s40, 4
  s_add_u32 s68, s68, s40
  s_add_u32 s68, s68, 2516992
  v_readlane_b32 s44, v60, s43
  v_readlane_b32 s45, v61, s43
  s_add_u32 s43, s43, 4
  s_nop 2
  s_waitcnt vmcnt(5)
  buffer_load_dwordx4 v[160:163], v3, s[32:35], s44 offen offset:0 nt
  s_waitcnt vmcnt(5)
  buffer_load_dwordx4 v[164:167], v3, s[32:35], s45 offen offset:0 nt
  s_waitcnt vmcnt(5)
  buffer_load_dwordx4 v[168:171], v3, s[32:35], s44 offen offset:128 nt
  s_waitcnt vmcnt(5)
  buffer_load_dwordx4 v[172:175], v3, s[32:35], s45 offen offset:128 nt
  s_waitcnt vmcnt(5)
  buffer_load_dwordx4 v[176:179], v3, s[32:35], s44 offen offset:256 nt
  s_waitcnt vmcnt(5)
  buffer_load_dwordx4 v[180:183], v3, s[32:35], s45 offen offset:256 nt
  v_readlane_b32 s44, v60, s43
  v_readlane_b32 s45, v61, s43
  s_add_u32 s43, s43, 4
  s_nop 2
  s_waitcnt vmcnt(5)
  buffer_load_dwordx4 v[184:187], v3, s[32:35], s44 offen offset:0 nt
  s_waitcnt vmcnt(5)
  buffer_load_dwordx4 v[188:191], v3, s[32:35], s45 offen offset:0 nt
  s_waitcnt vmcnt(5)
  buffer_load_dwordx4 v[192:195], v3, s[32:35], s44 offen offset:128 nt
  s_waitcnt vmcnt(5)
  buffer_load_dwordx4 v[196:199], v3, s[32:35], s45 offen offset:128 nt
  s_waitcnt vmcnt(5)
  buffer_load_dwordx4 v[200:203], v3, s[32:35], s44 offen offset:256 nt
  s_waitcnt vmcnt(5)
  buffer_load_dwordx4 v[204:207], v3, s[32:35], s45 offen offset:256 nt
  v_readlane_b32 s44, v60, s43
  v_readlane_b32 s45, v61, s43
  s_add_u32 s43, s43, 4
  s_nop 2
  s_waitcnt vmcnt(5)
  buffer_load_dwordx4 v[208:211], v3, s[32:35], s44 offen offset:0 nt
  s_waitcnt vmcnt(5)
  buffer_load_dwordx4 v[212:215], v3, s[32:35], s45 offen offset:0 nt
  s_waitcnt vmcnt(5)
  buffer_load_dwordx4 v[216:219], v3, s[32:35], s44 offen offset:128 nt
  s_waitcnt vmcnt(5)
  buffer_load_dwordx4 v[220:223], v3, s[32:35], s45 offen offset:128 nt
  s_waitcnt vmcnt(5)
  buffer_load_dwordx4 v[224:227], v3, s[32:35], s44 offen offset:256 nt
  s_waitcnt vmcnt(5)
  buffer_load_dwordx4 v[228:231], v3, s[32:35], s45 offen offset:256 nt
  v_readlane_b32 s44, v60, s43
  v_readlane_b32 s45, v61, s43
  s_add_u32 s43, s43, 4
  s_nop 2
  s_waitcnt vmcnt(5)
  buffer_load_dwordx4 v[232:235], v3, s[32:35], s44 offen offset:0 nt
  s_waitcnt vmcnt(5)
  buffer_load_dwordx4 v[236:239], v3, s[32:35], s45 offen offset:0 nt
  s_waitcnt vmcnt(5)
  buffer_load_dwordx4 v[240:243], v3, s[32:35], s44 offen offset:128 nt
  s_waitcnt lgkmcnt(0)
  ds_read_b32 v54, v5 offset:404
  ds_read_b128 v[8:11], v6 offset:1536
  ds_read_b128 v[12:15], v6 offset:1664
  ds_read_b128 v[16:19], v6 offset:1792
  s_add_u32 s55, s55, 2654435769
  v_mov_b32 v26, s55
  v_and_b32 v27, 0xff, v26
  s_movk_i32 s50, 2048
  s_waitcnt vmcnt(5)
  buffer_load_dwordx4 v[244:247], v3, s[32:35], s45 offen offset:128 nt
  s_waitcnt vmcnt(5)
  buffer_load_dwordx4 v[248:251], v3, s[32:35], s44 offen offset:256 nt
  s_waitcnt vmcnt(5)
  buffer_load_dwordx4 v[252:255], v3, s[32:35], s45 offen offset:256 nt
  s_waitcnt lgkmcnt(0)
  v_cmp_eq_u32 vcc, 0, v54
  s_cbranch_vccz L_qhave
  s_mov_b32 s51, 1048576
L_qw:
  ds_read_b32 v53, v5 offset:404
  s_waitcnt lgkmcnt(0)
  v_cmp_gt_u32 vcc, 1, v53
  s_cbranch_vccz L_qwok
  s_sub_u32 s51, s51, 1
  s_cbranch_scc0 L_qw
L_qwok:
  ds_read_b128 v[8:11], v6 offset:1536
  ds_read_b128 v[12:15], v6 offset:1664
  ds_read_b128 v[16:19], v6 offset:1792
  s_waitcnt lgkmcnt(0)
L_qhave:
  s_mov_b32 s51, 13
  s_cmp_lg_u32 s30, 0
  s_cbranch_scc1 L_side
  s_setprio 3
L_kloop:
  s_and_b32 s40, s51, 3
  s_cmp_gt_u32 s40, 1
  s_cbranch_scc1 L_kgo
  s_cmp_eq_u32 s40, 0
  s_cbranch_scc1 L_knb
  s_add_u32 s32, s32, 50331648
  s_addc_u32 s33, s33, 0
  v_add_u32 v62, 384, v62
  ds_read_b32 v54, v5 offset:404
  ds_read_b128 v[40:43], v62 offset:1536
  ds_read_b128 v[44:47], v62 offset:1664
  ds_read_b128 v[48:51], v62 offset:1792
  s_cmp_lg_u32 s51, 1
  s_cbranch_scc1 L_kgo
  s_add_u32 s32, s8, s31
  s_addc_u32 s33, s9, 0
  s_branch L_kgo
L_knb:
  v_cmp_gt_u32 vcc, 2, v54
  s_cbranch_vccz L_kq
  s_mov_b32 s53, s51
  s_mov_b32 s51, 1048576
L_q2:
  ds_read_b32 v53, v5 offset:404
  s_waitcnt lgkmcnt(0)
  v_cmp_gt_u32 vcc, 2, v53
  s_cbranch_vccz L_q2ok
  s_sub_u32 s51, s51, 1
  s_cbranch_scc0 L_q2
L_q2ok:
  s_mov_b32 s51, s53
  ds_read_b128 v[40:43], v62 offset:1536
  ds_read_b128 v[44:47], v62 offset:1664
  ds_read_b128 v[48:51], v62 offset:1792
  s_waitcnt lgkmcnt(0)
L_kq:
  v_mov_b64 v[8:9], v[40:41]
  v_mov_b64 v[10:11], v[42:43]
  v_mov_b64 v[12:13], v[44:45]
  v_mov_b64 v[14:15], v[46:47]
  v_mov_b64 v[16:17], v[48:49]
  v_mov_b64 v[18:19], v[50:51]
L_kgo:
  v_readlane_b32 s44, v60, s43
  v_readlane_b32 s45, v61, s43
  s_add_u32 s43, s43, 1
  s_waitcnt lgkmcnt(6)
  v_readfirstlane_b32 s54, v58
  s_nop 0
  s_bfe_u32 s42, s54, 262144
  v_dot2_f32_bf16 v20, v64, v8, 0
  v_dot2_f32_bf16 v21, v68, v8, 0
  v_dot2_f32_bf16 v20, v65, v9, v20
  v_dot2_f32_bf16 v21, v69, v9, v21
  v_dot2_f32_bf16 v20, v66, v10, v20
  v_dot2_f32_bf16 v21, v70, v10, v21
  v_dot2_f32_bf16 v20, v67, v11, v20
  v_dot2_f32_bf16 v21, v71, v11, v21
  s_waitcnt vmcnt(24)
  s_cmp_eq_u32 s42, 0
  s_cbranch_scc1 L_k0_0
  s_waitcnt vmcnt(22)
  s_cmp_eq_u32 s42, 1
  s_cbranch_scc1 L_k0_0
  s_waitcnt vmcnt(21)
  s_cmp_eq_u32 s42, 2
  s_cbranch_scc1 L_k0_0
  s_waitcnt vmcnt(20)
  s_cmp_eq_u32 s42, 3
  s_cbranch_scc1 L_k0_0
  s_waitcnt vmcnt(19)
  s_cmp_eq_u32 s42, 4
  s_cbranch_scc1 L_k0_0
  s_waitcnt vmcnt(18)
  s_cmp_eq_u32 s42, 5
  s_cbranch_scc1 L_k0_0
  s_waitcnt vmcnt(17)
  s_cmp_eq_u32 s42, 6
  s_cbranch_scc1 L_k0_0
  s_waitcnt vmcnt(16)
  s_cmp_eq_u32 s42, 7
  s_cbranch_scc1 L_k0_0
  s_waitcnt vmcnt(15)
  s_cmp_eq_u32 s42, 8
  s_cbranch_scc1 L_k0_0
  s_waitcnt vmcnt(13)
L_k0_0:
  buffer_load_dwordx4 v[64:67], v3, s[32:35], s44 offen offset:0 nt
  buffer_load_dwordx4 v[68:71], v3, s[32:35], s45 offen offset:0 nt
  v_dot2_f32_bf16 v20, v72, v12, v20
  v_dot2_f32_bf16 v21, v76, v12, v21
  v_dot2_f32_bf16 v20, v73, v13, v20
  v_dot2_f32_bf16 v21, v77, v13, v21
  v_dot2_f32_bf16 v20, v74, v14, v20
  v_dot2_f32_bf16 v21, v78, v14, v21
  v_dot2_f32_bf16 v20, v75, v15, v20
  v_dot2_f32_bf16 v21, v79, v15, v21
  buffer_load_dwordx4 v[72:75], v3, s[32:35], s44 offen offset:128 nt
  buffer_load_dwordx4 v[76:79], v3, s[32:35], s45 offen offset:128 nt
  v_dot2_f32_bf16 v20, v80, v16, v20
  v_dot2_f32_bf16 v21, v84, v16, v21
  v_dot2_f32_bf16 v20, v81, v17, v20
  v_dot2_f32_bf16 v21, v85, v17, v21
  v_dot2_f32_bf16 v20, v82, v18, v20
  v_dot2_f32_bf16 v21, v86, v18, v21
  v_dot2_f32_bf16 v20, v83, v19, v20
  v_dot2_f32_bf16 v21, v87, v19, v21
  buffer_load_dwordx4 v[80:83], v3, s[32:35], s44 offen offset:256 nt
  buffer_load_dwordx4 v[84:87], v3, s[32:35], s45 offen offset:256 nt
  v_add_u32 v56, 6, v56
  ds_write_b64 v4, v[20:21]
  ds_write_b32 v57, v56 offset:512
  v_add_u32 v4, s50, v4
  v_readlane_b32 s44, v60, s43
  v_readlane_b32 s45, v61, s43
  s_add_u32 s43, s43, 1
  ds_read_b32 v58, v5 offset:400
  s_bfe_u32 s42, s54, 262148
  v_dot2_f32_bf16 v20, v88, v8, 0
  v_dot2_f32_bf16 v21, v92, v8, 0
  v_dot2_f32_bf16 v20, v89, v9, v20
  v_dot2_f32_bf16 v21, v93, v9, v21
  v_dot2_f32_bf16 v20, v90, v10, v20
  v_dot2_f32_bf16 v21, v94, v10, v21
  v_dot2_f32_bf16 v20, v91, v11, v20
  v_dot2_f32_bf16 v21, v95, v11, v21
  s_waitcnt vmcnt(24)
  s_cmp_eq_u32 s42, 0
  s_cbranch_scc1 L_k1_0
  s_waitcnt vmcnt(22)
  s_cmp_eq_u32 s42, 1
  s_cbranch_scc1 L_k1_0
  s_waitcnt vmcnt(21)
  s_cmp_eq_u32 s42, 2
  s_cbranch_scc1 L_k1_0
  s_waitcnt vmcnt(20)
  s_cmp_eq_u32 s42, 3
  s_cbranch_scc1 L_k1_0
  s_waitcnt vmcnt(19)
  s_cmp_eq_u32 s42, 4
  s_cbranch_scc1 L_k1_0
  s_waitcnt vmcnt(18)
  s_cmp_eq_u32 s42, 5
  s_cbranch_scc1 L_k1_0
  s_waitcnt vmcnt(17)
  s_cmp_eq_u32 s42, 6
  s_cbranch_scc1 L_k1_0
  s_waitcnt vmcnt(16)
  s_cmp_eq_u32 s42, 7
  s_cbranch_scc1 L_k1_0
  s_waitcnt vmcnt(15)
  s_cmp_eq_u32 s42, 8
  s_cbranch_scc1 L_k1_0
  s_waitcnt vmcnt(13)
L_k1_0:
  buffer_load_dwordx4 v[88:91], v3, s[32:35], s44 offen offset:0 nt
  buffer_load_dwordx4 v[92:95], v3, s[32:35], s45 offen offset:0 nt
  v_dot2_f32_bf16 v20, v96, v12, v20
  v_dot2_f32_bf16 v21, v100, v12, v21
  v_dot2_f32_bf16 v20, v97, v13, v20
  v_dot2_f32_bf16 v21, v101, v13, v21
  v_dot2_f32_bf16 v20, v98, v14, v20
  v_dot2_f32_bf16 v21, v102, v14, v21
  v_dot2_f32_bf16 v20, v99, v15, v20
  v_dot2_f32_bf16 v21, v103, v15, v21
  buffer_load_dwordx4 v[96:99], v3, s[32:35], s44 offen offset:128 nt
  buffer_load_dwordx4 v[100:103], v3, s[32:35], s45 offen offset:128 nt
  v_dot2_f32_bf16 v20, v104, v16, v20
  v_dot2_f32_bf16 v21, v108, v16, v21
  v_dot2_f32_bf16 v20, v105, v17, v20
  v_dot2_f32_bf16 v21, v109, v17, v21
  v_dot2_f32_bf16 v20, v106, v18, v20
  v_dot2_f32_bf16 v21, v110, v18, v21
  v_dot2_f32_bf16 v20, v107, v19, v20
  v_dot2_f32_bf16 v21, v111, v19, v21
  buffer_load_dwordx4 v[104:107], v3, s[32:35], s44 offen offset:256 nt
  buffer_load_dwordx4 v[108:111], v3, s[32:35], s45 offen offset:256 nt
  v_add_u32 v56, 6, v56
  ds_write_b64 v4, v[20:21]
  ds_write_b32 v57, v56 offset:512
  v_add_u32 v4, s50, v4
  v_readlane_b32 s44, v60, s43
  v_readlane_b32 s45, v61, s43
  s_add_u32 s43, s43, 1
  s_waitcnt lgkmcnt(2)
  v_readfirstlane_b32 s54, v58
  s_nop 0
  s_bfe_u32 s42, s54, 262144
  v_dot2_f32_bf16 v20, v112, v8, 0
  v_dot2_f32_bf16 v21, v116, v8, 0
  v_dot2_f32_bf16 v20, v113, v9, v20
  v_dot2_f32_bf16 v21, v117, v9, v21
  v_dot2_f32_bf16 v20, v114, v10, v20
  v_dot2_f32_bf16 v21, v118, v10, v21
  v_dot2_f32_bf16 v20, v115, v11, v20
  v_dot2_f32_bf16 v21, v119, v11, v21
  s_waitcnt vmcnt(24)
  s_cmp_eq_u32 s42, 0
  s_cbranch_scc1 L_k2_0
  s_waitcnt vmcnt(22)
  s_cmp_eq_u32 s42, 1
  s_cbranch_scc1 L_k2_0
  s_waitcnt vmcnt(21)
  s_cmp_eq_u32 s42, 2
  s_cbranch_scc1 L_k2_0
  s_waitcnt vmcnt(20)
  s_cmp_eq_u32 s42, 3
  s_cbranch_scc1 L_k2_0
  s_waitcnt vmcnt(19)
  s_cmp_eq_u32 s42, 4
  s_cbranch_scc1 L_k2_0
  s_waitcnt vmcnt(18)
  s_cmp_eq_u32 s42, 5
  s_cbranch_scc1 L_k2_0
  s_waitcnt vmcnt(17)
  s_cmp_eq_u32 s42, 6
  s_cbranch_scc1 L_k2_0
  s_waitcnt vmcnt(16)
  s_cmp_eq_u32 s42, 7
  s_cbranch_scc1 L_k2_0
  s_waitcnt vmcnt(15)
  s_cmp_eq_u32 s42, 8
  s_cbranch_scc1 L_k2_0
  s_waitcnt vmcnt(13)
L_k2_0:
  buffer_load_dwordx4 v[112:115], v3, s[32:35], s44 offen offset:0 nt
  buffer_load_dwordx4 v[116:119], v3, s[32:35], s45 offen offset:0 nt
  v_dot2_f32_bf16 v20, v120, v12, v20
  v_dot2_f32_bf16 v21, v124, v12, v21
  v_dot2_f32_bf16 v20, v121, v13, v20
  v_dot2_f32_bf16 v21, v125, v13, v21
  v_dot2_f32_bf16 v20, v122, v14, v20
  v_dot2_f32_bf16 v21, v126, v14, v21
  v_dot2_f32_bf16 v20, v123, v15, v20
  v_dot2_f32_bf16 v21, v127, v15, v21
  buffer_load_dwordx4 v[120:123], v3, s[32:35], s44 offen offset:128 nt
  buffer_load_dwordx4 v[124:127], v3, s[32:35], s45 offen offset:128 nt
  v_dot2_f32_bf16 v20, v128, v16, v20
  v_dot2_f32_bf16 v21, v132, v16, v21
  v_dot2_f32_bf16 v20, v129, v17, v20
  v_dot2_f32_bf16 v21, v133, v17, v21
  v_dot2_f32_bf16 v20, v130, v18, v20
  v_dot2_f32_bf16 v21, v134, v18, v21
  v_dot2_f32_bf16 v20, v131, v19, v20
  v_dot2_f32_bf16 v21, v135, v19, v21
  buffer_load_dwordx4 v[128:131], v3, s[32:35], s44 offen offset:256 nt
  buffer_load_dwordx4 v[132:135], v3, s[32:35], s45 offen offset:256 nt
  v_add_u32 v56, 6, v56
  ds_write_b64 v4, v[20:21]
  ds_write_b32 v57, v56 offset:512
  v_add_u32 v4, s50, v4
  v_readlane_b32 s44, v60, s43
  v_readlane_b32 s45, v61, s43
  s_add_u32 s43, s43, 1
  ds_read_b32 v58, v5 offset:400
  s_bfe_u32 s42, s54, 262148
  v_dot2_f32_bf16 v20, v136, v8, 0
  v_dot2_f32_bf16 v21, v140, v8, 0
  v_dot2_f32_bf16 v20, v137, v9, v20
  v_dot2_f32_bf16 v21, v141, v9, v21
  v_dot2_f32_bf16 v20, v138, v10, v20
  v_dot2_f32_bf16 v21, v142, v10, v21
  v_dot2_f32_bf16 v20, v139, v11, v20
  v_dot2_f32_bf16 v21, v143, v11, v21
  s_waitcnt vmcnt(24)
  s_cmp_eq_u32 s42, 0
  s_cbranch_scc1 L_k3_0
  s_waitcnt vmcnt(22)
  s_cmp_eq_u32 s42, 1
  s_cbranch_scc1 L_k3_0
  s_waitcnt vmcnt(21)
  s_cmp_eq_u32 s42, 2
  s_cbranch_scc1 L_k3_0
  s_waitcnt vmcnt(20)
  s_cmp_eq_u32 s42, 3
  s_cbranch_scc1 L_k3_0
  s_waitcnt vmcnt(19)
  s_cmp_eq_u32 s42, 4
  s_cbranch_scc1 L_k3_0
  s_waitcnt vmcnt(18)
  s_cmp_eq_u32 s42, 5
  s_cbranch_scc1 L_k3_0
  s_waitcnt vmcnt(17)
  s_cmp_eq_u32 s42, 6
  s_cbranch_scc1 L_k3_0
  s_waitcnt vmcnt(16)
  s_cmp_eq_u32 s42, 7
  s_cbranch_scc1 L_k3_0
  s_waitcnt vmcnt(15)
  s_cmp_eq_u32 s42, 8
  s_cbranch_scc1 L_k3_0
  s_waitcnt vmcnt(13)
L_k3_0:
  buffer_load_dwordx4 v[136:139], v3, s[32:35], s44 offen offset:0 nt
  buffer_load_dwordx4 v[140:143], v3, s[32:35], s45 offen offset:0 nt
  v_dot2_f32_bf16 v20, v144, v12, v20
  v_dot2_f32_bf16 v21, v148, v12, v21
  v_dot2_f32_bf16 v20, v145, v13, v20
  v_dot2_f32_bf16 v21, v149, v13, v21
  v_dot2_f32_bf16 v20, v146, v14, v20
  v_dot2_f32_bf16 v21, v150, v14, v21
  v_dot2_f32_bf16 v20, v147, v15, v20
  v_dot2_f32_bf16 v21, v151, v15, v21
  buffer_load_dwordx4 v[144:147], v3, s[32:35], s44 offen offset:128 nt
  buffer_load_dwordx4 v[148:151], v3, s[32:35], s45 offen offset:128 nt
  v_dot2_f32_bf16 v20, v152, v16, v20
  v_dot2_f32_bf16 v21, v156, v16, v21
  v_dot2_f32_bf16 v20, v153, v17, v20
  v_dot2_f32_bf16 v21, v157, v17, v21
  v_dot2_f32_bf16 v20, v154, v18, v20
  v_dot2_f32_bf16 v21, v158, v18, v21
  v_dot2_f32_bf16 v20, v155, v19, v20
  v_dot2_f32_bf16 v21, v159, v19, v21
  buffer_load_dwordx4 v[152:155], v3, s[32:35], s44 offen offset:256 nt
  buffer_load_dwordx4 v[156:159], v3, s[32:35], s45 offen offset:256 nt
  v_add_u32 v56, 6, v56
  ds_write_b64 v4, v[20:21]
  ds_write_b32 v57, v56 offset:512
  v_add_u32 v4, s50, v4
  v_readlane_b32 s44, v60, s43
  v_readlane_b32 s45, v61, s43
  s_add_u32 s43, s43, 1
  s_waitcnt lgkmcnt(2)
  v_readfirstlane_b32 s54, v58
  s_nop 0
  s_bfe_u32 s42, s54, 262144
  v_dot2_f32_bf16 v20, v160, v8, 0
  v_dot2_f32_bf16 v21, v164, v8, 0
  v_dot2_f32_bf16 v20, v161, v9, v20
  v_dot2_f32_bf16 v21, v165, v9, v21
  v_dot2_f32_bf16 v20, v162, v10, v20
  v_dot2_f32_bf16 v21, v166, v10, v21
  v_dot2_f32_bf16 v20, v163, v11, v20
  v_dot2_f32_bf16 v21, v167, v11, v21
  s_waitcnt vmcnt(24)
  s_cmp_eq_u32 s42, 0
  s_cbranch_scc1 L_k4_0
  s_waitcnt vmcnt(22)
  s_cmp_eq_u32 s42, 1
  s_cbranch_scc1 L_k4_0
  s_waitcnt vmcnt(21)
  s_cmp_eq_u32 s42, 2
  s_cbranch_scc1 L_k4_0
  s_waitcnt vmcnt(20)
  s_cmp_eq_u32 s42, 3
  s_cbranch_scc1 L_k4_0
  s_waitcnt vmcnt(19)
  s_cmp_eq_u32 s42, 4
  s_cbranch_scc1 L_k4_0
  s_waitcnt vmcnt(18)
  s_cmp_eq_u32 s42, 5
  s_cbranch_scc1 L_k4_0
  s_waitcnt vmcnt(17)
  s_cmp_eq_u32 s42, 6
  s_cbranch_scc1 L_k4_0
  s_waitcnt vmcnt(16)
  s_cmp_eq_u32 s42, 7
  s_cbranch_scc1 L_k4_0
  s_waitcnt vmcnt(15)
  s_cmp_eq_u32 s42, 8
  s_cbranch_scc1 L_k4_0
  s_waitcnt vmcnt(13)
L_k4_0:
  buffer_load_dwordx4 v[160:163], v3, s[32:35], s44 offen offset:0 nt
  buffer_load_dwordx4 v[164:167], v3, s[32:35], s45 offen offset:0 nt
  v_dot2_f32_bf16 v20, v168, v12, v20
  v_dot2_f32_bf16 v21, v172, v12, v21
  v_dot2_f32_bf16 v20, v169, v13, v20
  v_dot2_f32_bf16 v21, v173, v13, v21
  v_dot2_f32_bf16 v20, v170, v14, v20
  v_dot2_f32_bf16 v21, v174, v14, v21
  v_dot2_f32_bf16 v20, v171, v15, v20
  v_dot2_f32_bf16 v21, v175, v15, v21
  buffer_load_dwordx4 v[168:171], v3, s[32:35], s44 offen offset:128 nt
  buffer_load_dwordx4 v[172:175], v3, s[32:35], s45 offen offset:128 nt
  v_dot2_f32_bf16 v20, v176, v16, v20
  v_dot2_f32_bf16 v21, v180, v16, v21
  v_dot2_f32_bf16 v20, v177, v17, v20
  v_dot2_f32_bf16 v21, v181, v17, v21
  v_dot2_f32_bf16 v20, v178, v18, v20
  v_dot2_f32_bf16 v21, v182, v18, v21
  v_dot2_f32_bf16 v20, v179, v19, v20
  v_dot2_f32_bf16 v21, v183, v19, v21
  buffer_load_dwordx4 v[176:179], v3, s[32:35], s44 offen offset:256 nt
  buffer_load_dwordx4 v[180:183], v3, s[32:35], s45 offen offset:256 nt
  v_add_u32 v56, 6, v56
  ds_write_b64 v4, v[20:21]
  ds_write_b32 v57, v56 offset:512
  v_add_u32 v4, s50, v4
  v_readlane_b32 s44, v60, s43
  v_readlane_b32 s45, v61, s43
  s_add_u32 s43, s43, 1
  ds_read_b32 v58, v5 offset:400
  s_bfe_u32 s42, s54, 262148
  v_dot2_f32_bf16 v20, v184, v8, 0
  v_dot2_f32_bf16 v21, v188, v8, 0
  v_dot2_f32_bf16 v20, v185, v9, v20
  v_dot2_f32_bf16 v21, v189, v9, v21
  v_dot2_f32_bf16 v20, v186, v10, v20
  v_dot2_f32_bf16 v21, v190, v10, v21
  v_dot2_f32_bf16 v20, v187, v11, v20
  v_dot2_f32_bf16 v21, v191, v11, v21
  s_waitcnt vmcnt(24)
  s_cmp_eq_u32 s42, 0
  s_cbranch_scc1 L_k5_0
  s_waitcnt vmcnt(22)
  s_cmp_eq_u32 s42, 1
  s_cbranch_scc1 L_k5_0
  s_waitcnt vmcnt(21)
  s_cmp_eq_u32 s42, 2
  s_cbranch_scc1 L_k5_0
  s_waitcnt vmcnt(20)
  s_cmp_eq_u32 s42, 3
  s_cbranch_scc1 L_k5_0
  s_waitcnt vmcnt(19)
  s_cmp_eq_u32 s42, 4
  s_cbranch_scc1 L_k5_0
  s_waitcnt vmcnt(18)
  s_cmp_eq_u32 s42, 5
  s_cbranch_scc1 L_k5_0
  s_waitcnt vmcnt(17)
  s_cmp_eq_u32 s42, 6
  s_cbranch_scc1 L_k5_0
  s_waitcnt vmcnt(16)
  s_cmp_eq_u32 s42, 7
  s_cbranch_scc1 L_k5_0
  s_waitcnt vmcnt(15)
  s_cmp_eq_u32 s42, 8
  s_cbranch_scc1 L_k5_0
  s_waitcnt vmcnt(13)
L_k5_0:
  buffer_load_dwordx4 v[184:187], v3, s[32:35], s44 offen offset:0 nt
  buffer_load_dwordx4 v[188:191], v3, s[32:35], s45 offen offset:0 nt
  v_dot2_f32_bf16 v20, v192, v12, v20
  v_dot2_f32_bf16 v21, v196, v12, v21
  v_dot2_f32_bf16 v20, v193, v13, v20
  v_dot2_f32_bf16 v21, v197, v13, v21
  v_dot2_f32_bf16 v20, v194, v14, v20
  v_dot2_f32_bf16 v21, v198, v14, v21
  v_dot2_f32_bf16 v20, v195, v15, v20
  v_dot2_f32_bf16 v21, v199, v15, v21
  buffer_load_dwordx4 v[192:195], v3, s[32:35], s44 offen offset:128 nt
  buffer_load_dwordx4 v[196:199], v3, s[32:35], s45 offen offset:128 nt
  v_dot2_f32_bf16 v20, v200, v16, v20
  v_dot2_f32_bf16 v21, v204, v16, v21
  v_dot2_f32_bf16 v20, v201, v17, v20
  v_dot2_f32_bf16 v21, v205, v17, v21
  v_dot2_f32_bf16 v20, v202, v18, v20
  v_dot2_f32_bf16 v21, v206, v18, v21
  v_dot2_f32_bf16 v20, v203, v19, v20
  v_dot2_f32_bf16 v21, v207, v19, v21
  buffer_load_dwordx4 v[200:203], v3, s[32:35], s44 offen offset:256 nt
  buffer_load_dwordx4 v[204:207], v3, s[32:35], s45 offen offset:256 nt
  v_add_u32 v56, 6, v56
  ds_write_b64 v4, v[20:21]
  ds_write_b32 v57, v56 offset:512
  v_add_u32 v4, s50, v4
  v_readlane_b32 s44, v60, s43
  v_readlane_b32 s45, v61, s43
  s_add_u32 s43, s43, 1
  s_waitcnt lgkmcnt(2)
  v_readfirstlane_b32 s54, v58
  s_nop 0
  s_bfe_u32 s42, s54, 262144
  v_dot2_f32_bf16 v20, v208, v8, 0
  v_dot2_f32_bf16 v21, v212, v8, 0
  v_dot2_f32_bf16 v20, v209, v9, v20
  v_dot2_f32_bf16 v21, v213, v9, v21
  v_dot2_f32_bf16 v20, v210, v10, v20
  v_dot2_f32_bf16 v21, v214, v10, v21
  v_dot2_f32_bf16 v20, v211, v11, v20
  v_dot2_f32_bf16 v21, v215, v11, v21
  s_waitcnt vmcnt(24)
  s_cmp_eq_u32 s42, 0
  s_cbranch_scc1 L_k6_0
  s_waitcnt vmcnt(22)
  s_cmp_eq_u32 s42, 1
  s_cbranch_scc1 L_k6_0
  s_waitcnt vmcnt(21)
  s_cmp_eq_u32 s42, 2
  s_cbranch_scc1 L_k6_0
  s_waitcnt vmcnt(20)
  s_cmp_eq_u32 s42, 3
  s_cbranch_scc1 L_k6_0
  s_waitcnt vmcnt(19)
  s_cmp_eq_u32 s42, 4
  s_cbranch_scc1 L_k6_0
  s_waitcnt vmcnt(18)
  s_cmp_eq_u32 s42, 5
  s_cbranch_scc1 L_k6_0
  s_waitcnt vmcnt(17)
  s_cmp_eq_u32 s42, 6
  s_cbranch_scc1 L_k6_0
  s_waitcnt vmcnt(16)
  s_cmp_eq_u32 s42, 7
  s_cbranch_scc1 L_k6_0
  s_waitcnt vmcnt(15)
  s_cmp_eq_u32 s42, 8
  s_cbranch_scc1 L_k6_0
  s_waitcnt vmcnt(13)
L_k6_0:
  buffer_load_dwordx4 v[208:211], v3, s[32:35], s44 offen offset:0 nt
  buffer_load_dwordx4 v[212:215], v3, s[32:35], s45 offen offset:0 nt
  v_dot2_f32_bf16 v20, v216, v12, v20
  v_dot2_f32_bf16 v21, v220, v12, v21
  v_dot2_f32_bf16 v20, v217, v13, v20
  v_dot2_f32_bf16 v21, v221, v13, v21
  v_dot2_f32_bf16 v20, v218, v14, v20
  v_dot2_f32_bf16 v21, v222, v14, v21
  v_dot2_f32_bf16 v20, v219, v15, v20
  v_dot2_f32_bf16 v21, v223, v15, v21
  buffer_load_dwordx4 v[216:219], v3, s[32:35], s44 offen offset:128 nt
  buffer_load_dwordx4 v[220:223], v3, s[32:35], s45 offen offset:128 nt
  v_dot2_f32_bf16 v20, v224, v16, v20
  v_dot2_f32_bf16 v21, v228, v16, v21
  v_dot2_f32_bf16 v20, v225, v17, v20
  v_dot2_f32_bf16 v21, v229, v17, v21
  v_dot2_f32_bf16 v20, v226, v18, v20
  v_dot2_f32_bf16 v21, v230, v18, v21
  v_dot2_f32_bf16 v20, v227, v19, v20
  v_dot2_f32_bf16 v21, v231, v19, v21
  buffer_load_dwordx4 v[224:227], v3, s[32:35], s44 offen offset:256 nt
  buffer_load_dwordx4 v[228:231], v3, s[32:35], s45 offen offset:256 nt
  v_add_u32 v56, 6, v56
  ds_write_b64 v4, v[20:21]
  ds_write_b32 v57, v56 offset:512
  v_add_u32 v4, s50, v4
  v_readlane_b32 s44, v60, s43
  v_readlane_b32 s45, v61, s43
  s_add_u32 s43, s43, 1
  ds_read_b32 v58, v5 offset:400
  s_bfe_u32 s42, s54, 262148
  v_dot2_f32_bf16 v20, v232, v8, 0
  v_dot2_f32_bf16 v21, v236, v8, 0
  v_dot2_f32_bf16 v20, v233, v9, v20
  v_dot2_f32_bf16 v21, v237, v9, v21
  v_dot2_f32_bf16 v20, v234, v10, v20
  v_dot2_f32_bf16 v21, v238, v10, v21
  v_dot2_f32_bf16 v20, v235, v11, v20
  v_dot2_f32_bf16 v21, v239, v11, v21
  s_waitcnt vmcnt(24)
  s_cmp_eq_u32 s42, 0
  s_cbranch_scc1 L_k7_0
  s_waitcnt vmcnt(22)
  s_cmp_eq_u32 s42, 1
  s_cbranch_scc1 L_k7_0
  s_waitcnt vmcnt(21)
  s_cmp_eq_u32 s42, 2
  s_cbranch_scc1 L_k7_0
  s_waitcnt vmcnt(20)
  s_cmp_eq_u32 s42, 3
  s_cbranch_scc1 L_k7_0
  s_waitcnt vmcnt(19)
  s_cmp_eq_u32 s42, 4
  s_cbranch_scc1 L_k7_0
  s_waitcnt vmcnt(18)
  s_cmp_eq_u32 s42, 5
  s_cbranch_scc1 L_k7_0
  s_waitcnt vmcnt(17)
  s_cmp_eq_u32 s42, 6
  s_cbranch_scc1 L_k7_0
  s_waitcnt vmcnt(16)
  s_cmp_eq_u32 s42, 7
  s_cbranch_scc1 L_k7_0
  s_waitcnt vmcnt(15)
  s_cmp_eq_u32 s42, 8
  s_cbranch_scc1 L_k7_0
  s_waitcnt vmcnt(13)
L_k7_0:
  buffer_load_dwordx4 v[232:235], v3, s[32:35], s44 offen offset:0 nt
  buffer_load_dwordx4 v[236:239], v3, s[32:35], s45 offen offset:0 nt
  v_dot2_f32_bf16 v20, v240, v12, v20
  v_dot2_f32_bf16 v21, v244, v12, v21
  v_dot2_f32_bf16 v20, v241, v13, v20
  v_dot2_f32_bf16 v21, v245, v13, v21
  v_dot2_f32_bf16 v20, v242, v14, v20
  v_dot2_f32_bf16 v21, v246, v14, v21
  v_dot2_f32_bf16 v20, v243, v15, v20
  v_dot2_f32_bf16 v21, v247, v15, v21
  buffer_load_dwordx4 v[240:243], v3, s[32:35], s44 offen offset:128 nt
  buffer_load_dwordx4 v[244:247], v3, s[32:35], s45 offen offset:128 nt
  v_dot2_f32_bf16 v20, v248, v16, v20
  v_dot2_f32_bf16 v21, v252, v16, v21
  v_dot2_f32_bf16 v20, v249, v17, v20
  v_dot2_f32_bf16 v21, v253, v17, v21
  v_dot2_f32_bf16 v20, v250, v18, v20
  v_dot2_f32_bf16 v21, v254, v18, v21
  v_dot2_f32_bf16 v20, v251, v19, v20
  v_dot2_f32_bf16 v21, v255, v19, v21
  buffer_load_dwordx4 v[248:251], v3, s[32:35], s44 offen offset:256 nt
  buffer_load_dwordx4 v[252:255], v3, s[32:35], s45 offen offset:256 nt
  v_add_u32 v56, 6, v56
  ds_write_b64 v4, v[20:21]
  ds_write_b32 v57, v56 offset:512
  v_add_u32 v4, s50, v4
  s_movk_i32 s50, 512
  s_sub_u32 s51, s51, 1
  s_cmp_lg_u32 s51, 0
  s_cbranch_scc1 L_kloop
  ds_read_b32 v55, v5 offset:412
  v_and_b32 v4, 56, v2
  v_mov_b64 v[40:41], 0
  v_mov_b64 v[42:43], 0
  v_mov_b64 v[44:45], 0
  v_mov_b64 v[46:47], 0
  v_mov_b64 v[48:49], 0
  v_mov_b64 v[50:51], 0
  v_bfe_u32 v16, v26, 0, 8
  v_bfe_u32 v17, v26, 8, 8
  v_bfe_u32 v18, v26, 16, 8
  v_bfe_u32 v19, v26, 24, 8
  s_mov_b32 s51, 1048576
L_pf:
  ds_read_b32 v53, v5 offset:424
  s_waitcnt lgkmcnt(0)
  v_cmp_gt_u32 vcc, 3, v53
  s_cbranch_vccz L_pfok
  s_sub_u32 s51, s51, 1
  s_cbranch_scc0 L_pf
L_pfok:
  ds_read_b64 v[24:25], v4 offset:12288
  v_readfirstlane_b32 s49, v55
  s_mov_b32 s51, 15
  s_waitcnt lgkmcnt(0)
L_vloop:
  s_add_u32 s40, s51, 1
  s_and_b32 s40, s40, 3
  s_cmp_gt_u32 s40, 1
  s_cbranch_scc1 L_vgo
  s_cmp_eq_u32 s40, 0
  s_cbranch_scc1 L_vfl
  s_add_u32 s32, s32, 50331648
  s_addc_u32 s33, s33, 0
  s_cmp_lg_u32 s51, 8
  s_cbranch_scc1 L_vgo
  s_mov_b32 s51, 1048576
L_pf3:
  ds_read_b32 v53, v5 offset:428
  s_waitcnt lgkmcnt(0)
  v_cmp_gt_u32 vcc, 1, v53
  s_cbranch_vccz L_pf3ok
  s_sub_u32 s51, s51, 1
  s_cbranch_scc0 L_pf3
L_pf3ok:
  s_mov_b32 s51, 8
  s_branch L_vgo
L_vfl:
  s_cmp_eq_u32 s51, 15
  s_cbranch_scc1 L_vgo
  s_cmp_lg_u32 s49, 1
  v_permlane32_swap_b32 v40, v44
  v_permlane32_swap_b32 v41, v45
  v_permlane32_swap_b32 v42, v46
  v_permlane32_swap_b32 v43, v47
  v_permlane32_swap_b32 v48, v12
  v_permlane32_swap_b32 v49, v13
  v_permlane32_swap_b32 v50, v14
  v_permlane32_swap_b32 v51, v15
  v_add_f32_dpp v40, v44, v40 row_ror:8 row_mask:0xf bank_mask:0xf
  v_add_f32_dpp v41, v45, v41 row_ror:8 row_mask:0xf bank_mask:0xf
  v_add_f32_dpp v42, v46, v42 row_ror:8 row_mask:0xf bank_mask:0xf
  v_add_f32_dpp v43, v47, v43 row_ror:8 row_mask:0xf bank_mask:0xf
  v_add_f32_dpp v40, v48, v12 row_ror:8 row_mask:0x3 bank_mask:0xc
  v_add_f32_dpp v41, v49, v13 row_ror:8 row_mask:0x3 bank_mask:0xc
  v_add_f32_dpp v42, v50, v14 row_ror:8 row_mask:0x3 bank_mask:0xc
  v_add_f32_dpp v43, v51, v15 row_ror:8 row_mask:0x3 bank_mask:0xc
  s_mov_b32 exec_hi, 0x00ff00ff
  v_bfi_b32 v8, s77, v16, v40
  v_bfi_b32 v9, s77, v17, v41
  v_bfi_b32 v10, s77, v18, v42
  v_bfi_b32 v11, s77, v19, v43
  s_cbranch_scc1 L_obf
  buffer_store_dwordx4 v[8:11], v59, s[64:67], s68 offen
L_obd:
  s_mov_b64 exec, -1
  s_add_u32 s68, s68, 6272
  v_mov_b64 v[40:41], 0
  v_mov_b64 v[42:43], 0
  v_mov_b64 v[44:45], 0
  v_mov_b64 v[46:47], 0
  v_mov_b64 v[48:49], 0
  v_mov_b64 v[50:51], 0
L_vgo:
  v_readlane_b32 s44, v60, s43
  v_readlane_b32 s45, v61, s43
  s_add_u32 s43, s43, 1
  s_waitcnt lgkmcnt(2)
  v_readfirstlane_b32 s54, v58
  s_nop 0
  s_bfe_u32 s42, s54, 262144
  s_waitcnt lgkmcnt(1)
  v_and_b32 v32, v24, v28
  v_and_b32 v33, v24, v29
  v_and_b32 v34, v24, v30
  v_and_b32 v35, v24, v31
  v_and_b32 v36, v25, v28
  v_and_b32 v37, v25, v29
  v_and_b32 v38, v25, v30
  v_and_b32 v39, v25, v31
  ds_read_b64 v[24:25], v4 offset:12352
  v_mfma_f32_16x16x32_bf16 v[40:43], v[32:35], v[64:67], v[40:43]
  s_waitcnt vmcnt(24)
  s_cmp_eq_u32 s42, 0
  s_cbranch_scc1 L_v0_0
  s_waitcnt vmcnt(22)
  s_cmp_eq_u32 s42, 1
  s_cbranch_scc1 L_v0_0
  s_waitcnt vmcnt(21)
  s_cmp_eq_u32 s42, 2
  s_cbranch_scc1 L_v0_0
  s_waitcnt vmcnt(20)
  s_cmp_eq_u32 s42, 3
  s_cbranch_scc1 L_v0_0
  s_waitcnt vmcnt(19)
  s_cmp_eq_u32 s42, 4
  s_cbranch_scc1 L_v0_0
  s_waitcnt vmcnt(18)
  s_cmp_eq_u32 s42, 5
  s_cbranch_scc1 L_v0_0
  s_waitcnt vmcnt(17)
  s_cmp_eq_u32 s42, 6
  s_cbranch_scc1 L_v0_0
  s_waitcnt vmcnt(16)
  s_cmp_eq_u32 s42, 7
  s_cbranch_scc1 L_v0_0
  s_waitcnt vmcnt(15)
  s_cmp_eq_u32 s42, 8
  s_cbranch_scc1 L_v0_0
  s_waitcnt vmcnt(13)
L_v0_0:
  buffer_load_dwordx4 v[64:67], v3, s[32:35], s44 offen offset:0 nt
  v_mfma_f32_16x16x32_bf16 v[40:43], v[36:39], v[68:71], v[40:43]
  buffer_load_dwordx4 v[68:71], v3, s[32:35], s45 offen offset:0 nt
  v_mfma_f32_16x16x32_bf16 v[44:47], v[32:35], v[72:75], v[44:47]
  buffer_load_dwordx4 v[72:75], v3, s[32:35], s44 offen offset:128 nt
  v_mfma_f32_16x16x32_bf16 v[44:47], v[36:39], v[76:79], v[44:47]
  buffer_load_dwordx4 v[76:79], v3, s[32:35], s45 offen offset:128 nt
  v_mfma_f32_16x16x32_bf16 v[48:51], v[32:35], v[80:83], v[48:51]
  buffer_load_dwordx4 v[80:83], v3, s[32:35], s44 offen offset:256 nt
  v_mfma_f32_16x16x32_bf16 v[48:51], v[36:39], v[84:87], v[48:51]
  buffer_load_dwordx4 v[84:87], v3, s[32:35], s45 offen offset:256 nt
  v_add_u32 v56, 6, v56
  ds_write_b32 v57, v56 offset:512
  v_readlane_b32 s44, v60, s43
  v_readlane_b32 s45, v61, s43
  s_add_u32 s43, s43, 1
  ds_read_b32 v58, v5 offset:400
  s_bfe_u32 s42, s54, 262148
  s_waitcnt lgkmcnt(2)
  v_and_b32 v32, v24, v28
  v_and_b32 v33, v24, v29
  v_and_b32 v34, v24, v30
  v_and_b32 v35, v24, v31
  v_and_b32 v36, v25, v28
  v_and_b32 v37, v25, v29
  v_and_b32 v38, v25, v30
  v_and_b32 v39, v25, v31
  ds_read_b64 v[24:25], v4 offset:12416
  v_mfma_f32_16x16x32_bf16 v[40:43], v[32:35], v[88:91], v[40:43]
  s_waitcnt vmcnt(24)
  s_cmp_eq_u32 s42, 0
  s_cbranch_scc1 L_v1_0
  s_waitcnt vmcnt(22)
  s_cmp_eq_u32 s42, 1
  s_cbranch_scc1 L_v1_0
  s_waitcnt vmcnt(21)
  s_cmp_eq_u32 s42, 2
  s_cbranch_scc1 L_v1_0
  s_waitcnt vmcnt(20)
  s_cmp_eq_u32 s42, 3
  s_cbranch_scc1 L_v1_0
  s_waitcnt vmcnt(19)
  s_cmp_eq_u32 s42, 4
  s_cbranch_scc1 L_v1_0
  s_waitcnt vmcnt(18)
  s_cmp_eq_u32 s42, 5
  s_cbranch_scc1 L_v1_0
  s_waitcnt vmcnt(17)
  s_cmp_eq_u32 s42, 6
  s_cbranch_scc1 L_v1_0
  s_waitcnt vmcnt(16)
  s_cmp_eq_u32 s42, 7
  s_cbranch_scc1 L_v1_0
  s_waitcnt vmcnt(15)
  s_cmp_eq_u32 s42, 8
  s_cbranch_scc1 L_v1_0
  s_waitcnt vmcnt(13)
L_v1_0:
  buffer_load_dwordx4 v[88:91], v3, s[32:35], s44 offen offset:0 nt
  v_mfma_f32_16x16x32_bf16 v[40:43], v[36:39], v[92:95], v[40:43]
  buffer_load_dwordx4 v[92:95], v3, s[32:35], s45 offen offset:0 nt
  v_mfma_f32_16x16x32_bf16 v[44:47], v[32:35], v[96:99], v[44:47]
  buffer_load_dwordx4 v[96:99], v3, s[32:35], s44 offen offset:128 nt
  v_mfma_f32_16x16x32_bf16 v[44:47], v[36:39], v[100:103], v[44:47]
  buffer_load_dwordx4 v[100:103], v3, s[32:35], s45 offen offset:128 nt
  v_mfma_f32_16x16x32_bf16 v[48:51], v[32:35], v[104:107], v[48:51]
  buffer_load_dwordx4 v[104:107], v3, s[32:35], s44 offen offset:256 nt
  v_mfma_f32_16x16x32_bf16 v[48:51], v[36:39], v[108:111], v[48:51]
  buffer_load_dwordx4 v[108:111], v3, s[32:35], s45 offen offset:256 nt
  v_add_u32 v56, 6, v56
  ds_write_b32 v57, v56 offset:512
  v_readlane_b32 s44, v60, s43
  v_readlane_b32 s45, v61, s43
  s_add_u32 s43, s43, 1
  s_waitcnt lgkmcnt(2)
  v_readfirstlane_b32 s54, v58
  s_nop 0
  s_bfe_u32 s42, s54, 262144
  s_waitcnt lgkmcnt(1)
  v_and_b32 v32, v24, v28
  v_and_b32 v33, v24, v29
  v_and_b32 v34, v24, v30
  v_and_b32 v35, v24, v31
  v_and_b32 v36, v25, v28
  v_and_b32 v37, v25, v29
  v_and_b32 v38, v25, v30
  v_and_b32 v39, v25, v31
  ds_read_b64 v[24:25], v4 offset:12480
  v_mfma_f32_16x16x32_bf16 v[40:43], v[32:35], v[112:115], v[40:43]
  s_waitcnt vmcnt(24)
  s_cmp_eq_u32 s42, 0
  s_cbranch_scc1 L_v2_0
  s_waitcnt vmcnt(22)
  s_cmp_eq_u32 s42, 1
  s_cbranch_scc1 L_v2_0
  s_waitcnt vmcnt(21)
  s_cmp_eq_u32 s42, 2
  s_cbranch_scc1 L_v2_0
  s_waitcnt vmcnt(20)
  s_cmp_eq_u32 s42, 3
  s_cbranch_scc1 L_v2_0
  s_waitcnt vmcnt(19)
  s_cmp_eq_u32 s42, 4
  s_cbranch_scc1 L_v2_0
  s_waitcnt vmcnt(18)
  s_cmp_eq_u32 s42, 5
  s_cbranch_scc1 L_v2_0
  s_waitcnt vmcnt(17)
  s_cmp_eq_u32 s42, 6
  s_cbranch_scc1 L_v2_0
  s_waitcnt vmcnt(16)
  s_cmp_eq_u32 s42, 7
  s_cbranch_scc1 L_v2_0
  s_waitcnt vmcnt(15)
  s_cmp_eq_u32 s42, 8
  s_cbranch_scc1 L_v2_0
  s_waitcnt vmcnt(13)
L_v2_0:
  buffer_load_dwordx4 v[112:115], v3, s[32:35], s44 offen offset:0 nt
  v_mfma_f32_16x16x32_bf16 v[40:43], v[36:39], v[116:119], v[40:43]
  buffer_load_dwordx4 v[116:119], v3, s[32:35], s45 offen offset:0 nt
  v_mfma_f32_16x16x32_bf16 v[44:47], v[32:35], v[120:123], v[44:47]
  buffer_load_dwordx4 v[120:123], v3, s[32:35], s44 offen offset:128 nt
  v_mfma_f32_16x16x32_bf16 v[44:47], v[36:39], v[124:127], v[44:47]
  buffer_load_dwordx4 v[124:127], v3, s[32:35], s45 offen offset:128 nt
  v_mfma_f32_16x16x32_bf16 v[48:51], v[32:35], v[128:131], v[48:51]
  buffer_load_dwordx4 v[128:131], v3, s[32:35], s44 offen offset:256 nt
  v_mfma_f32_16x16x32_bf16 v[48:51], v[36:39], v[132:135], v[48:51]
  buffer_load_dwordx4 v[132:135], v3, s[32:35], s45 offen offset:256 nt
  v_add_u32 v56, 6, v56
  ds_write_b32 v57, v56 offset:512
  v_readlane_b32 s44, v60, s43
  v_readlane_b32 s45, v61, s43
  s_add_u32 s43, s43, 1
  ds_read_b32 v58, v5 offset:400
  s_bfe_u32 s42, s54, 262148
  s_waitcnt lgkmcnt(2)
  v_and_b32 v32, v24, v28
  v_and_b32 v33, v24, v29
  v_and_b32 v34, v24, v30
  v_and_b32 v35, v24, v31
  v_and_b32 v36, v25, v28
  v_and_b32 v37, v25, v29
  v_and_b32 v38, v25, v30
  v_and_b32 v39, v25, v31
  ds_read_b64 v[24:25], v4 offset:12544
  v_mfma_f32_16x16x32_bf16 v[40:43], v[32:35], v[136:139], v[40:43]
  s_waitcnt vmcnt(24)
  s_cmp_eq_u32 s42, 0
  s_cbranch_scc1 L_v3_0
  s_waitcnt vmcnt(22)
  s_cmp_eq_u32 s42, 1
  s_cbranch_scc1 L_v3_0
  s_waitcnt vmcnt(21)
  s_cmp_eq_u32 s42, 2
  s_cbranch_scc1 L_v3_0
  s_waitcnt vmcnt(20)
  s_cmp_eq_u32 s42, 3
  s_cbranch_scc1 L_v3_0
  s_waitcnt vmcnt(19)
  s_cmp_eq_u32 s42, 4
  s_cbranch_scc1 L_v3_0
  s_waitcnt vmcnt(18)
  s_cmp_eq_u32 s42, 5
  s_cbranch_scc1 L_v3_0
  s_waitcnt vmcnt(17)
  s_cmp_eq_u32 s42, 6
  s_cbranch_scc1 L_v3_0
  s_waitcnt vmcnt(16)
  s_cmp_eq_u32 s42, 7
  s_cbranch_scc1 L_v3_0
  s_waitcnt vmcnt(15)
  s_cmp_eq_u32 s42, 8
  s_cbranch_scc1 L_v3_0
  s_waitcnt vmcnt(13)
L_v3_0:
  buffer_load_dwordx4 v[136:139], v3, s[32:35], s44 offen offset:0 nt
  v_mfma_f32_16x16x32_bf16 v[40:43], v[36:39], v[140:143], v[40:43]
  buffer_load_dwordx4 v[140:143], v3, s[32:35], s45 offen offset:0 nt
  v_mfma_f32_16x16x32_bf16 v[44:47], v[32:35], v[144:147], v[44:47]
  buffer_load_dwordx4 v[144:147], v3, s[32:35], s44 offen offset:128 nt
  v_mfma_f32_16x16x32_bf16 v[44:47], v[36:39], v[148:151], v[44:47]
  buffer_load_dwordx4 v[148:151], v3, s[32:35], s45 offen offset:128 nt
  v_mfma_f32_16x16x32_bf16 v[48:51], v[32:35], v[152:155], v[48:51]
  buffer_load_dwordx4 v[152:155], v3, s[32:35], s44 offen offset:256 nt
  v_mfma_f32_16x16x32_bf16 v[48:51], v[36:39], v[156:159], v[48:51]
  buffer_load_dwordx4 v[156:159], v3, s[32:35], s45 offen offset:256 nt
  v_add_u32 v56, 6, v56
  ds_write_b32 v57, v56 offset:512
  v_readlane_b32 s44, v60, s43
  v_readlane_b32 s45, v61, s43
  s_add_u32 s43, s43, 1
  s_waitcnt lgkmcnt(2)
  v_readfirstlane_b32 s54, v58
  s_nop 0
  s_bfe_u32 s42, s54, 262144
  s_waitcnt lgkmcnt(1)
  v_and_b32 v32, v24, v28
  v_and_b32 v33, v24, v29
  v_and_b32 v34, v24, v30
  v_and_b32 v35, v24, v31
  v_and_b32 v36, v25, v28
  v_and_b32 v37, v25, v29
  v_and_b32 v38, v25, v30
  v_and_b32 v39, v25, v31
  ds_read_b64 v[24:25], v4 offset:12608
  v_mfma_f32_16x16x32_bf16 v[40:43], v[32:35], v[160:163], v[40:43]
  s_waitcnt vmcnt(24)
  s_cmp_eq_u32 s42, 0
  s_cbranch_scc1 L_v4_0
  s_waitcnt vmcnt(22)
  s_cmp_eq_u32 s42, 1
  s_cbranch_scc1 L_v4_0
  s_waitcnt vmcnt(21)
  s_cmp_eq_u32 s42, 2
  s_cbranch_scc1 L_v4_0
  s_waitcnt vmcnt(20)
  s_cmp_eq_u32 s42, 3
  s_cbranch_scc1 L_v4_0
  s_waitcnt vmcnt(19)
  s_cmp_eq_u32 s42, 4
  s_cbranch_scc1 L_v4_0
  s_waitcnt vmcnt(18)
  s_cmp_eq_u32 s42, 5
  s_cbranch_scc1 L_v4_0
  s_waitcnt vmcnt(17)
  s_cmp_eq_u32 s42, 6
  s_cbranch_scc1 L_v4_0
  s_waitcnt vmcnt(16)
  s_cmp_eq_u32 s42, 7
  s_cbranch_scc1 L_v4_0
  s_waitcnt vmcnt(15)
  s_cmp_eq_u32 s42, 8
  s_cbranch_scc1 L_v4_0
  s_waitcnt vmcnt(13)
L_v4_0:
  buffer_load_dwordx4 v[160:163], v3, s[32:35], s44 offen offset:0 nt
  v_mfma_f32_16x16x32_bf16 v[40:43], v[36:39], v[164:167], v[40:43]
  buffer_load_dwordx4 v[164:167], v3, s[32:35], s45 offen offset:0 nt
  v_mfma_f32_16x16x32_bf16 v[44:47], v[32:35], v[168:171], v[44:47]
  buffer_load_dwordx4 v[168:171], v3, s[32:35], s44 offen offset:128 nt
  v_mfma_f32_16x16x32_bf16 v[44:47], v[36:39], v[172:175], v[44:47]
  buffer_load_dwordx4 v[172:175], v3, s[32:35], s45 offen offset:128 nt
  v_mfma_f32_16x16x32_bf16 v[48:51], v[32:35], v[176:179], v[48:51]
  buffer_load_dwordx4 v[176:179], v3, s[32:35], s44 offen offset:256 nt
  v_mfma_f32_16x16x32_bf16 v[48:51], v[36:39], v[180:183], v[48:51]
  buffer_load_dwordx4 v[180:183], v3, s[32:35], s45 offen offset:256 nt
  v_add_u32 v56, 6, v56
  ds_write_b32 v57, v56 offset:512
  v_readlane_b32 s44, v60, s43
  v_readlane_b32 s45, v61, s43
  s_add_u32 s43, s43, 1
  ds_read_b32 v58, v5 offset:400
  s_bfe_u32 s42, s54, 262148
  s_waitcnt lgkmcnt(2)
  v_and_b32 v32, v24, v28
  v_and_b32 v33, v24, v29
  v_and_b32 v34, v24, v30
  v_and_b32 v35, v24, v31
  v_and_b32 v36, v25, v28
  v_and_b32 v37, v25, v29
  v_and_b32 v38, v25, v30
  v_and_b32 v39, v25, v31
  ds_read_b64 v[24:25], v4 offset:12672
  v_mfma_f32_16x16x32_bf16 v[40:43], v[32:35], v[184:187], v[40:43]
  s_waitcnt vmcnt(24)
  s_cmp_eq_u32 s42, 0
  s_cbranch_scc1 L_v5_0
  s_waitcnt vmcnt(22)
  s_cmp_eq_u32 s42, 1
  s_cbranch_scc1 L_v5_0
  s_waitcnt vmcnt(21)
  s_cmp_eq_u32 s42, 2
  s_cbranch_scc1 L_v5_0
  s_waitcnt vmcnt(20)
  s_cmp_eq_u32 s42, 3
  s_cbranch_scc1 L_v5_0
  s_waitcnt vmcnt(19)
  s_cmp_eq_u32 s42, 4
  s_cbranch_scc1 L_v5_0
  s_waitcnt vmcnt(18)
  s_cmp_eq_u32 s42, 5
  s_cbranch_scc1 L_v5_0
  s_waitcnt vmcnt(17)
  s_cmp_eq_u32 s42, 6
  s_cbranch_scc1 L_v5_0
  s_waitcnt vmcnt(16)
  s_cmp_eq_u32 s42, 7
  s_cbranch_scc1 L_v5_0
  s_waitcnt vmcnt(15)
  s_cmp_eq_u32 s42, 8
  s_cbranch_scc1 L_v5_0
  s_waitcnt vmcnt(13)
L_v5_0:
  buffer_load_dwordx4 v[184:187], v3, s[32:35], s44 offen offset:0 nt
  v_mfma_f32_16x16x32_bf16 v[40:43], v[36:39], v[188:191], v[40:43]
  buffer_load_dwordx4 v[188:191], v3, s[32:35], s45 offen offset:0 nt
  v_mfma_f32_16x16x32_bf16 v[44:47], v[32:35], v[192:195], v[44:47]
  buffer_load_dwordx4 v[192:195], v3, s[32:35], s44 offen offset:128 nt
  v_mfma_f32_16x16x32_bf16 v[44:47], v[36:39], v[196:199], v[44:47]
  buffer_load_dwordx4 v[196:199], v3, s[32:35], s45 offen offset:128 nt
  v_mfma_f32_16x16x32_bf16 v[48:51], v[32:35], v[200:203], v[48:51]
  buffer_load_dwordx4 v[200:203], v3, s[32:35], s44 offen offset:256 nt
  v_mfma_f32_16x16x32_bf16 v[48:51], v[36:39], v[204:207], v[48:51]
  buffer_load_dwordx4 v[204:207], v3, s[32:35], s45 offen offset:256 nt
  v_add_u32 v56, 6, v56
  ds_write_b32 v57, v56 offset:512
  v_readlane_b32 s44, v60, s43
  v_readlane_b32 s45, v61, s43
  s_add_u32 s43, s43, 1
  s_waitcnt lgkmcnt(2)
  v_readfirstlane_b32 s54, v58
  s_nop 0
  s_bfe_u32 s42, s54, 262144
  s_waitcnt lgkmcnt(1)
  v_and_b32 v32, v24, v28
  v_and_b32 v33, v24, v29
  v_and_b32 v34, v24, v30
  v_and_b32 v35, v24, v31
  v_and_b32 v36, v25, v28
  v_and_b32 v37, v25, v29
  v_and_b32 v38, v25, v30
  v_and_b32 v39, v25, v31
  ds_read_b64 v[24:25], v4 offset:12736
  v_mfma_f32_16x16x32_bf16 v[40:43], v[32:35], v[208:211], v[40:43]
  s_waitcnt vmcnt(24)
  s_cmp_eq_u32 s42, 0
  s_cbranch_scc1 L_v6_0
  s_waitcnt vmcnt(22)
  s_cmp_eq_u32 s42, 1
  s_cbranch_scc1 L_v6_0
  s_waitcnt vmcnt(21)
  s_cmp_eq_u32 s42, 2
  s_cbranch_scc1 L_v6_0
  s_waitcnt vmcnt(20)
  s_cmp_eq_u32 s42, 3
  s_cbranch_scc1 L_v6_0
  s_waitcnt vmcnt(19)
  s_cmp_eq_u32 s42, 4
  s_cbranch_scc1 L_v6_0
  s_waitcnt vmcnt(18)
  s_cmp_eq_u32 s42, 5
  s_cbranch_scc1 L_v6_0
  s_waitcnt vmcnt(17)
  s_cmp_eq_u32 s42, 6
  s_cbranch_scc1 L_v6_0
  s_waitcnt vmcnt(16)
  s_cmp_eq_u32 s42, 7
  s_cbranch_scc1 L_v6_0
  s_waitcnt vmcnt(15)
  s_cmp_eq_u32 s42, 8
  s_cbranch_scc1 L_v6_0
  s_waitcnt vmcnt(13)
L_v6_0:
  buffer_load_dwordx4 v[208:211], v3, s[32:35], s44 offen offset:0 nt
  v_mfma_f32_16x16x32_bf16 v[40:43], v[36:39], v[212:215], v[40:43]
  buffer_load_dwordx4 v[212:215], v3, s[32:35], s45 offen offset:0 nt
  v_mfma_f32_16x16x32_bf16 v[44:47], v[32:35], v[216:219], v[44:47]
  buffer_load_dwordx4 v[216:219], v3, s[32:35], s44 offen offset:128 nt
  v_mfma_f32_16x16x32_bf16 v[44:47], v[36:39], v[220:223], v[44:47]
  buffer_load_dwordx4 v[220:223], v3, s[32:35], s45 offen offset:128 nt
  v_mfma_f32_16x16x32_bf16 v[48:51], v[32:35], v[224:227], v[48:51]
  buffer_load_dwordx4 v[224:227], v3, s[32:35], s44 offen offset:256 nt
  v_mfma_f32_16x16x32_bf16 v[48:51], v[36:39], v[228:231], v[48:51]
  buffer_load_dwordx4 v[228:231], v3, s[32:35], s45 offen offset:256 nt
  v_add_u32 v56, 6, v56
  ds_write_b32 v57, v56 offset:512
  v_readlane_b32 s44, v60, s43
  v_readlane_b32 s45, v61, s43
  s_add_u32 s43, s43, 1
  ds_read_b32 v58, v5 offset:400
  s_bfe_u32 s42, s54, 262148
  s_waitcnt lgkmcnt(2)
  v_and_b32 v32, v24, v28
  v_and_b32 v33, v24, v29
  v_and_b32 v34, v24, v30
  v_and_b32 v35, v24, v31
  v_and_b32 v36, v25, v28
  v_and_b32 v37, v25, v29
  v_and_b32 v38, v25, v30
  v_and_b32 v39, v25, v31
  ds_read_b64 v[24:25], v4 offset:12800
  v_mfma_f32_16x16x32_bf16 v[40:43], v[32:35], v[232:235], v[40:43]
  s_waitcnt vmcnt(24)
  s_cmp_eq_u32 s42, 0
  s_cbranch_scc1 L_v7_0
  s_waitcnt vmcnt(22)
  s_cmp_eq_u32 s42, 1
  s_cbranch_scc1 L_v7_0
  s_waitcnt vmcnt(21)
  s_cmp_eq_u32 s42, 2
  s_cbranch_scc1 L_v7_0
  s_waitcnt vmcnt(20)
  s_cmp_eq_u32 s42, 3
  s_cbranch_scc1 L_v7_0
  s_waitcnt vmcnt(19)
  s_cmp_eq_u32 s42, 4
  s_cbranch_scc1 L_v7_0
  s_waitcnt vmcnt(18)
  s_cmp_eq_u32 s42, 5
  s_cbranch_scc1 L_v7_0
  s_waitcnt vmcnt(17)
  s_cmp_eq_u32 s42, 6
  s_cbranch_scc1 L_v7_0
  s_waitcnt vmcnt(16)
  s_cmp_eq_u32 s42, 7
  s_cbranch_scc1 L_v7_0
  s_waitcnt vmcnt(15)
  s_cmp_eq_u32 s42, 8
  s_cbranch_scc1 L_v7_0
  s_waitcnt vmcnt(13)
L_v7_0:
  buffer_load_dwordx4 v[232:235], v3, s[32:35], s44 offen offset:0 nt
  v_mfma_f32_16x16x32_bf16 v[40:43], v[36:39], v[236:239], v[40:43]
  buffer_load_dwordx4 v[236:239], v3, s[32:35], s45 offen offset:0 nt
  v_mfma_f32_16x16x32_bf16 v[44:47], v[32:35], v[240:243], v[44:47]
  buffer_load_dwordx4 v[240:243], v3, s[32:35], s44 offen offset:128 nt
  v_mfma_f32_16x16x32_bf16 v[44:47], v[36:39], v[244:247], v[44:47]
  buffer_load_dwordx4 v[244:247], v3, s[32:35], s45 offen offset:128 nt
  v_mfma_f32_16x16x32_bf16 v[48:51], v[32:35], v[248:251], v[48:51]
  buffer_load_dwordx4 v[248:251], v3, s[32:35], s44 offen offset:256 nt
  v_mfma_f32_16x16x32_bf16 v[48:51], v[36:39], v[252:255], v[48:51]
  buffer_load_dwordx4 v[252:255], v3, s[32:35], s45 offen offset:256 nt
  v_add_u32 v56, 6, v56
  ds_write_b32 v57, v56 offset:512
  v_add_u32 v4, 512, v4
  s_sub_u32 s51, s51, 1
  s_cmp_lg_u32 s51, 0
  s_cbranch_scc1 L_vloop
  s_waitcnt lgkmcnt(0)
  v_and_b32 v32, v24, v28
  v_and_b32 v33, v24, v29
  v_and_b32 v34, v24, v30
  v_and_b32 v35, v24, v31
  v_and_b32 v36, v25, v28
  v_and_b32 v37, v25, v29
  v_and_b32 v38, v25, v30
  v_and_b32 v39, v25, v31
  ds_read_b64 v[24:25], v4 offset:12352
  s_waitcnt vmcnt(47)
  v_mfma_f32_16x16x32_bf16 v[40:43], v[32:35], v[64:67], v[40:43]
  s_waitcnt vmcnt(46)
  v_mfma_f32_16x16x32_bf16 v[40:43], v[36:39], v[68:71], v[40:43]
  s_waitcnt vmcnt(45)
  v_mfma_f32_16x16x32_bf16 v[44:47], v[32:35], v[72:75], v[44:47]
  s_waitcnt vmcnt(44)
  v_mfma_f32_16x16x32_bf16 v[44:47], v[36:39], v[76:79], v[44:47]
  s_waitcnt vmcnt(43)
  v_mfma_f32_16x16x32_bf16 v[48:51], v[32:35], v[80:83], v[48:51]
  s_waitcnt vmcnt(42)
  v_mfma_f32_16x16x32_bf16 v[48:51], v[36:39], v[84:87], v[48:51]
  s_waitcnt lgkmcnt(0)
  v_and_b32 v32, v24, v28
  v_and_b32 v33, v24, v29
  v_and_b32 v34, v24, v30
  v_and_b32 v35, v24, v31
  v_and_b32 v36, v25, v28
  v_and_b32 v37, v25, v29
  v_and_b32 v38, v25, v30
  v_and_b32 v39, v25, v31
  ds_read_b64 v[24:25], v4 offset:12416
  s_waitcnt vmcnt(41)
  v_mfma_f32_16x16x32_bf16 v[40:43], v[32:35], v[88:91], v[40:43]
  s_waitcnt vmcnt(40)
  v_mfma_f32_16x16x32_bf16 v[40:43], v[36:39], v[92:95], v[40:43]
  s_waitcnt vmcnt(39)
  v_mfma_f32_16x16x32_bf16 v[44:47], v[32:35], v[96:99], v[44:47]
  s_waitcnt vmcnt(38)
  v_mfma_f32_16x16x32_bf16 v[44:47], v[36:39], v[100:103], v[44:47]
  s_waitcnt vmcnt(37)
  v_mfma_f32_16x16x32_bf16 v[48:51], v[32:35], v[104:107], v[48:51]
  s_waitcnt vmcnt(36)
  v_mfma_f32_16x16x32_bf16 v[48:51], v[36:39], v[108:111], v[48:51]
  s_waitcnt lgkmcnt(0)
  v_and_b32 v32, v24, v28
  v_and_b32 v33, v24, v29
  v_and_b32 v34, v24, v30
  v_and_b32 v35, v24, v31
  v_and_b32 v36, v25, v28
  v_and_b32 v37, v25, v29
  v_and_b32 v38, v25, v30
  v_and_b32 v39, v25, v31
  ds_read_b64 v[24:25], v4 offset:12480
  s_waitcnt vmcnt(35)
  v_mfma_f32_16x16x32_bf16 v[40:43], v[32:35], v[112:115], v[40:43]
  s_waitcnt vmcnt(34)
  v_mfma_f32_16x16x32_bf16 v[40:43], v[36:39], v[116:119], v[40:43]
  s_waitcnt vmcnt(33)
  v_mfma_f32_16x16x32_bf16 v[44:47], v[32:35], v[120:123], v[44:47]
  s_waitcnt vmcnt(32)
  v_mfma_f32_16x16x32_bf16 v[44:47], v[36:39], v[124:127], v[44:47]
  s_waitcnt vmcnt(31)
  v_mfma_f32_16x16x32_bf16 v[48:51], v[32:35], v[128:131], v[48:51]
  s_waitcnt vmcnt(30)
  v_mfma_f32_16x16x32_bf16 v[48:51], v[36:39], v[132:135], v[48:51]
  s_waitcnt vmcnt(15)
  v_add_u32 v56, 1, v56
  ds_write_b32 v57, v56 offset:512
  s_waitcnt lgkmcnt(0)
  v_and_b32 v32, v24, v28
  v_and_b32 v33, v24, v29
  v_and_b32 v34, v24, v30
  v_and_b32 v35, v24, v31
  v_and_b32 v36, v25, v28
  v_and_b32 v37, v25, v29
  v_and_b32 v38, v25, v30
  v_and_b32 v39, v25, v31
  ds_read_b64 v[24:25], v4 offset:12544
  s_waitcnt vmcnt(29)
  v_mfma_f32_16x16x32_bf16 v[40:43], v[32:35], v[136:139], v[40:43]
  s_waitcnt vmcnt(28)
  v_mfma_f32_16x16x32_bf16 v[40:43], v[36:39], v[140:143], v[40:43]
  s_waitcnt vmcnt(27)
  v_mfma_f32_16x16x32_bf16 v[44:47], v[32:35], v[144:147], v[44:47]
  s_waitcnt vmcnt(26)
  v_mfma_f32_16x16x32_bf16 v[44:47], v[36:39], v[148:151], v[44:47]
  s_waitcnt vmcnt(25)
  v_mfma_f32_16x16x32_bf16 v[48:51], v[32:35], v[152:155], v[48:51]
  s_waitcnt vmcnt(24)
  v_mfma_f32_16x16x32_bf16 v[48:51], v[36:39], v[156:159], v[48:51]
  s_waitcnt lgkmcnt(0)
  v_and_b32 v32, v24, v28
  v_and_b32 v33, v24, v29
  v_and_b32 v34, v24, v30
  v_and_b32 v35, v24, v31
  v_and_b32 v36, v25, v28
  v_and_b32 v37, v25, v29
  v_and_b32 v38, v25, v30
  v_and_b32 v39, v25, v31
  ds_read_b64 v[24:25], v4 offset:12608
  s_waitcnt vmcnt(23)
  v_mfma_f32_16x16x32_bf16 v[40:43], v[32:35], v[160:163], v[40:43]
  s_waitcnt vmcnt(22)
  v_mfma_f32_16x16x32_bf16 v[40:43], v[36:39], v[164:167], v[40:43]
  s_waitcnt vmcnt(21)
  v_mfma_f32_16x16x32_bf16 v[44:47], v[32:35], v[168:171], v[44:47]
  s_waitcnt vmcnt(20)
  v_mfma_f32_16x16x32_bf16 v[44:47], v[36:39], v[172:175], v[44:47]
  s_waitcnt vmcnt(19)
  v_mfma_f32_16x16x32_bf16 v[48:51], v[32:35], v[176:179], v[48:51]
  s_waitcnt vmcnt(18)
  v_mfma_f32_16x16x32_bf16 v[48:51], v[36:39], v[180:183], v[48:51]
  s_waitcnt lgkmcnt(0)
  v_and_b32 v32, v24, v28
  v_and_b32 v33, v24, v29
  v_and_b32 v34, v24, v30
  v_and_b32 v35, v24, v31
  v_and_b32 v36, v25, v28
  v_and_b32 v37, v25, v29
  v_and_b32 v38, v25, v30
  v_and_b32 v39, v25, v31
  ds_read_b64 v[24:25], v4 offset:12672
  s_waitcnt vmcnt(17)
  v_mfma_f32_16x16x32_bf16 v[40:43], v[32:35], v[184:187], v[40:43]
  s_waitcnt vmcnt(16)
  v_mfma_f32_16x16x32_bf16 v[40:43], v[36:39], v[188:191], v[40:43]
  s_waitcnt vmcnt(15)
  v_mfma_f32_16x16x32_bf16 v[44:47], v[32:35], v[192:195], v[44:47]
  s_waitcnt vmcnt(14)
  v_mfma_f32_16x16x32_bf16 v[44:47], v[36:39], v[196:199], v[44:47]
  s_waitcnt vmcnt(13)
  v_mfma_f32_16x16x32_bf16 v[48:51], v[32:35], v[200:203], v[48:51]
  s_waitcnt vmcnt(12)
  v_mfma_f32_16x16x32_bf16 v[48:51], v[36:39], v[204:207], v[48:51]
  s_waitcnt lgkmcnt(0)
  v_and_b32 v32, v24, v28
  v_and_b32 v33, v24, v29
  v_and_b32 v34, v24, v30
  v_and_b32 v35, v24, v31
  v_and_b32 v36, v25, v28
  v_and_b32 v37, v25, v29
  v_and_b32 v38, v25, v30
  v_and_b32 v39, v25, v31
  ds_read_b64 v[24:25], v4 offset:12736
  s_waitcnt vmcnt(11)
  v_mfma_f32_16x16x32_bf16 v[40:43], v[32:35], v[208:211], v[40:43]
  s_waitcnt vmcnt(10)
  v_mfma_f32_16x16x32_bf16 v[40:43], v[36:39], v[212:215], v[40:43]
  s_waitcnt vmcnt(9)
  v_mfma_f32_16x16x32_bf16 v[44:47], v[32:35], v[216:219], v[44:47]
  s_waitcnt vmcnt(9)
  v_add_u32 v56, 1, v56
  ds_write_b32 v57, v56 offset:512
  s_waitcnt vmcnt(8)
  v_mfma_f32_16x16x32_bf16 v[44:47], v[36:39], v[220:223], v[44:47]
  s_waitcnt vmcnt(7)
  v_mfma_f32_16x16x32_bf16 v[48:51], v[32:35], v[224:227], v[48:51]
  s_waitcnt vmcnt(6)
  v_mfma_f32_16x16x32_bf16 v[48:51], v[36:39], v[228:231], v[48:51]
  s_waitcnt lgkmcnt(0)
  v_and_b32 v32, v24, v28
  v_and_b32 v33, v24, v29
  v_and_b32 v34, v24, v30
  v_and_b32 v35, v24, v31
  v_and_b32 v36, v25, v28
  v_and_b32 v37, v25, v29
  v_and_b32 v38, v25, v30
  v_and_b32 v39, v25, v31
  s_nop 0
  s_waitcnt vmcnt(5)
  v_mfma_f32_16x16x32_bf16 v[40:43], v[32:35], v[232:235], v[40:43]
  s_waitcnt vmcnt(4)
  v_mfma_f32_16x16x32_bf16 v[40:43], v[36:39], v[236:239], v[40:43]
  s_waitcnt vmcnt(3)
  v_mfma_f32_16x16x32_bf16 v[44:47], v[32:35], v[240:243], v[44:47]
  s_waitcnt vmcnt(3)
  v_add_u32 v56, 1, v56
  ds_write_b32 v57, v56 offset:512
  s_waitcnt vmcnt(2)
  v_mfma_f32_16x16x32_bf16 v[44:47], v[36:39], v[244:247], v[44:47]
  s_waitcnt vmcnt(1)
  v_mfma_f32_16x16x32_bf16 v[48:51], v[32:35], v[248:251], v[48:51]
  s_waitcnt vmcnt(0)
  v_mfma_f32_16x16x32_bf16 v[48:51], v[36:39], v[252:255], v[48:51]
  s_cmp_lg_u32 s49, 1
  s_nop 2
  v_permlane32_swap_b32 v40, v44
  v_permlane32_swap_b32 v41, v45
  v_permlane32_swap_b32 v42, v46
  v_permlane32_swap_b32 v43, v47
  v_permlane32_swap_b32 v48, v12
  v_permlane32_swap_b32 v49, v13
  v_permlane32_swap_b32 v50, v14
  v_permlane32_swap_b32 v51, v15
  v_add_f32_dpp v40, v44, v40 row_ror:8 row_mask:0xf bank_mask:0xf
  v_add_f32_dpp v41, v45, v41 row_ror:8 row_mask:0xf bank_mask:0xf
  v_add_f32_dpp v42, v46, v42 row_ror:8 row_mask:0xf bank_mask:0xf
  v_add_f32_dpp v43, v47, v43 row_ror:8 row_mask:0xf bank_mask:0xf
  v_add_f32_dpp v40, v48, v12 row_ror:8 row_mask:0x3 bank_mask:0xc
  v_add_f32_dpp v41, v49, v13 row_ror:8 row_mask:0x3 bank_mask:0xc
  v_add_f32_dpp v42, v50, v14 row_ror:8 row_mask:0x3 bank_mask:0xc
  v_add_f32_dpp v43, v51, v15 row_ror:8 row_mask:0x3 bank_mask:0xc
  s_mov_b32 exec_hi, 0x00ff00ff
  v_bfi_b32 v8, s77, v16, v40
  v_bfi_b32 v9, s77, v17, v41
  v_bfi_b32 v10, s77, v18, v42
  v_bfi_b32 v11, s77, v19, v43
  s_cbranch_scc1 L_opfar
  buffer_store_dwordx4 v[8:11], v59, s[64:67], s68 offen
  s_endpgm
L_opfar:
  buffer_store_dwordx4 v[8:11], v59, s[64:67], s68 offen sc1
L_opdone:
  s_endpgm
L_obf:
  buffer_store_dwordx4 v[8:11], v59, s[64:67], s68 offen sc1
  s_branch L_obd
L_side:
  s_waitcnt vmcnt(42)
  v_dot2_f32_bf16 v20, v64, v8, 0
  v_dot2_f32_bf16 v21, v68, v8, 0
  v_dot2_f32_bf16 v20, v65, v9, v20
  v_dot2_f32_bf16 v21, v69, v9, v21
  v_dot2_f32_bf16 v20, v66, v10, v20
  v_dot2_f32_bf16 v21, v70, v10, v21
  v_dot2_f32_bf16 v20, v67, v11, v20
  v_dot2_f32_bf16 v21, v71, v11, v21
  v_dot2_f32_bf16 v20, v72, v12, v20
  v_dot2_f32_bf16 v21, v76, v12, v21
  v_dot2_f32_bf16 v20, v73, v13, v20
  v_dot2_f32_bf16 v21, v77, v13, v21
  v_dot2_f32_bf16 v20, v74, v14, v20
  v_dot2_f32_bf16 v21, v78, v14, v21
  v_dot2_f32_bf16 v20, v75, v15, v20
  v_dot2_f32_bf16 v21, v79, v15, v21
  v_dot2_f32_bf16 v20, v80, v16, v20
  v_dot2_f32_bf16 v21, v84, v16, v21
  v_dot2_f32_bf16 v20, v81, v17, v20
  v_dot2_f32_bf16 v21, v85, v17, v21
  v_dot2_f32_bf16 v20, v82, v18, v20
  v_dot2_f32_bf16 v21, v86, v18, v21
  v_dot2_f32_bf16 v20, v83, v19, v20
  v_dot2_f32_bf16 v21, v87, v19, v21
  s_nop 2
  ds_write_b64 v4, v[20:21] offset:0
  s_waitcnt vmcnt(36)
  v_dot2_f32_bf16 v20, v88, v8, 0
  v_dot2_f32_bf16 v21, v92, v8, 0
  v_dot2_f32_bf16 v20, v89, v9, v20
  v_dot2_f32_bf16 v21, v93, v9, v21
  v_dot2_f32_bf16 v20, v90, v10, v20
  v_dot2_f32_bf16 v21, v94, v10, v21
  v_dot2_f32_bf16 v20, v91, v11, v20
  v_dot2_f32_bf16 v21, v95, v11, v21
  v_dot2_f32_bf16 v20, v96, v12, v20
  v_dot2_f32_bf16 v21, v100, v12, v21
  v_dot2_f32_bf16 v20, v97, v13, v20
  v_dot2_f32_bf16 v21, v101, v13, v21
  v_dot2_f32_bf16 v20, v98, v14, v20
  v_dot2_f32_bf16 v21, v102, v14, v21
  v_dot2_f32_bf16 v20, v99, v15, v20
  v_dot2_f32_bf16 v21, v103, v15, v21
  v_dot2_f32_bf16 v20, v104, v16, v20
  v_dot2_f32_bf16 v21, v108, v16, v21
  v_dot2_f32_bf16 v20, v105, v17, v20
  v_dot2_f32_bf16 v21, v109, v17, v21
  v_dot2_f32_bf16 v20, v106, v18, v20
  v_dot2_f32_bf16 v21, v110, v18, v21
  v_dot2_f32_bf16 v20, v107, v19, v20
  v_dot2_f32_bf16 v21, v111, v19, v21
  s_nop 2
  ds_write_b64 v4, v[20:21] offset:2048
  s_waitcnt vmcnt(30)
  v_dot2_f32_bf16 v20, v112, v8, 0
  v_dot2_f32_bf16 v21, v116, v8, 0
  v_dot2_f32_bf16 v20, v113, v9, v20
  v_dot2_f32_bf16 v21, v117, v9, v21
  v_dot2_f32_bf16 v20, v114, v10, v20
  v_dot2_f32_bf16 v21, v118, v10, v21
  v_dot2_f32_bf16 v20, v115, v11, v20
  v_dot2_f32_bf16 v21, v119, v11, v21
  v_dot2_f32_bf16 v20, v120, v12, v20
  v_dot2_f32_bf16 v21, v124, v12, v21
  v_dot2_f32_bf16 v20, v121, v13, v20
  v_dot2_f32_bf16 v21, v125, v13, v21
  v_dot2_f32_bf16 v20, v122, v14, v20
  v_dot2_f32_bf16 v21, v126, v14, v21
  v_dot2_f32_bf16 v20, v123, v15, v20
  v_dot2_f32_bf16 v21, v127, v15, v21
  v_dot2_f32_bf16 v20, v128, v16, v20
  v_dot2_f32_bf16 v21, v132, v16, v21
  v_dot2_f32_bf16 v20, v129, v17, v20
  v_dot2_f32_bf16 v21, v133, v17, v21
  v_dot2_f32_bf16 v20, v130, v18, v20
  v_dot2_f32_bf16 v21, v134, v18, v21
  v_dot2_f32_bf16 v20, v131, v19, v20
  v_dot2_f32_bf16 v21, v135, v19, v21
  s_nop 2
  ds_write_b64 v4, v[20:21] offset:4096
  s_waitcnt vmcnt(24)
  v_dot2_f32_bf16 v20, v136, v8, 0
  v_dot2_f32_bf16 v21, v140, v8, 0
  v_dot2_f32_bf16 v20, v137, v9, v20
  v_dot2_f32_bf16 v21, v141, v9, v21
  v_dot2_f32_bf16 v20, v138, v10, v20
  v_dot2_f32_bf16 v21, v142, v10, v21
  v_dot2_f32_bf16 v20, v139, v11, v20
  v_dot2_f32_bf16 v21, v143, v11, v21
  v_dot2_f32_bf16 v20, v144, v12, v20
  v_dot2_f32_bf16 v21, v148, v12, v21
  v_dot2_f32_bf16 v20, v145, v13, v20
  v_dot2_f32_bf16 v21, v149, v13, v21
  v_dot2_f32_bf16 v20, v146, v14, v20
  v_dot2_f32_bf16 v21, v150, v14, v21
  v_dot2_f32_bf16 v20, v147, v15, v20
  v_dot2_f32_bf16 v21, v151, v15, v21
  v_dot2_f32_bf16 v20, v152, v16, v20
  v_dot2_f32_bf16 v21, v156, v16, v21
  v_dot2_f32_bf16 v20, v153, v17, v20
  v_dot2_f32_bf16 v21, v157, v17, v21
  v_dot2_f32_bf16 v20, v154, v18, v20
  v_dot2_f32_bf16 v21, v158, v18, v21
  v_dot2_f32_bf16 v20, v155, v19, v20
  v_dot2_f32_bf16 v21, v159, v19, v21
  s_nop 2
  ds_write_b64 v4, v[20:21] offset:6144
  s_waitcnt vmcnt(18)
  v_dot2_f32_bf16 v20, v160, v8, 0
  v_dot2_f32_bf16 v21, v164, v8, 0
  v_dot2_f32_bf16 v20, v161, v9, v20
  v_dot2_f32_bf16 v21, v165, v9, v21
  v_dot2_f32_bf16 v20, v162, v10, v20
  v_dot2_f32_bf16 v21, v166, v10, v21
  v_dot2_f32_bf16 v20, v163, v11, v20
  v_dot2_f32_bf16 v21, v167, v11, v21
  v_dot2_f32_bf16 v20, v168, v12, v20
  v_dot2_f32_bf16 v21, v172, v12, v21
  v_dot2_f32_bf16 v20, v169, v13, v20
  v_dot2_f32_bf16 v21, v173, v13, v21
  v_dot2_f32_bf16 v20, v170, v14, v20
  v_dot2_f32_bf16 v21, v174, v14, v21
  v_dot2_f32_bf16 v20, v171, v15, v20
  v_dot2_f32_bf16 v21, v175, v15, v21
  v_dot2_f32_bf16 v20, v176, v16, v20
  v_dot2_f32_bf16 v21, v180, v16, v21
  v_dot2_f32_bf16 v20, v177, v17, v20
  v_dot2_f32_bf16 v21, v181, v17, v21
  v_dot2_f32_bf16 v20, v178, v18, v20
  v_dot2_f32_bf16 v21, v182, v18, v21
  v_dot2_f32_bf16 v20, v179, v19, v20
  v_dot2_f32_bf16 v21, v183, v19, v21
  s_nop 2
  ds_write_b64 v4, v[20:21] offset:8192
  s_waitcnt vmcnt(12)
  v_dot2_f32_bf16 v20, v184, v8, 0
  v_dot2_f32_bf16 v21, v188, v8, 0
  v_dot2_f32_bf16 v20, v185, v9, v20
  v_dot2_f32_bf16 v21, v189, v9, v21
  v_dot2_f32_bf16 v20, v186, v10, v20
  v_dot2_f32_bf16 v21, v190, v10, v21
  v_dot2_f32_bf16 v20, v187, v11, v20
  v_dot2_f32_bf16 v21, v191, v11, v21
  v_dot2_f32_bf16 v20, v192, v12, v20
  v_dot2_f32_bf16 v21, v196, v12, v21
  v_dot2_f32_bf16 v20, v193, v13, v20
  v_dot2_f32_bf16 v21, v197, v13, v21
  v_dot2_f32_bf16 v20, v194, v14, v20
  v_dot2_f32_bf16 v21, v198, v14, v21
  v_dot2_f32_bf16 v20, v195, v15, v20
  v_dot2_f32_bf16 v21, v199, v15, v21
  v_dot2_f32_bf16 v20, v200, v16, v20
  v_dot2_f32_bf16 v21, v204, v16, v21
  v_dot2_f32_bf16 v20, v201, v17, v20
  v_dot2_f32_bf16 v21, v205, v17, v21
  v_dot2_f32_bf16 v20, v202, v18, v20
  v_dot2_f32_bf16 v21, v206, v18, v21
  v_dot2_f32_bf16 v20, v203, v19, v20
  v_dot2_f32_bf16 v21, v207, v19, v21
  s_nop 2
  ds_write_b64 v4, v[20:21] offset:10240
  s_waitcnt vmcnt(6)
  v_dot2_f32_bf16 v20, v208, v8, 0
  v_dot2_f32_bf16 v21, v212, v8, 0
  v_dot2_f32_bf16 v20, v209, v9, v20
  v_dot2_f32_bf16 v21, v213, v9, v21
  v_dot2_f32_bf16 v20, v210, v10, v20
  v_dot2_f32_bf16 v21, v214, v10, v21
  v_dot2_f32_bf16 v20, v211, v11, v20
  v_dot2_f32_bf16 v21, v215, v11, v21
  v_dot2_f32_bf16 v20, v216, v12, v20
  v_dot2_f32_bf16 v21, v220, v12, v21
  v_dot2_f32_bf16 v20, v217, v13, v20
  v_dot2_f32_bf16 v21, v221, v13, v21
  v_dot2_f32_bf16 v20, v218, v14, v20
  v_dot2_f32_bf16 v21, v222, v14, v21
  v_dot2_f32_bf16 v20, v219, v15, v20
  v_dot2_f32_bf16 v21, v223, v15, v21
  v_dot2_f32_bf16 v20, v224, v16, v20
  v_dot2_f32_bf16 v21, v228, v16, v21
  v_dot2_f32_bf16 v20, v225, v17, v20
  v_dot2_f32_bf16 v21, v229, v17, v21
  v_dot2_f32_bf16 v20, v226, v18, v20
  v_dot2_f32_bf16 v21, v230, v18, v21
  v_dot2_f32_bf16 v20, v227, v19, v20
  v_dot2_f32_bf16 v21, v231, v19, v21
  s_nop 2
  ds_write_b64 v4, v[20:21] offset:12288
  s_waitcnt vmcnt(0)
  v_dot2_f32_bf16 v20, v232, v8, 0
  v_dot2_f32_bf16 v21, v236, v8, 0
  v_dot2_f32_bf16 v20, v233, v9, v20
  v_dot2_f32_bf16 v21, v237, v9, v21
  v_dot2_f32_bf16 v20, v234, v10, v20
  v_dot2_f32_bf16 v21, v238, v10, v21
  v_dot2_f32_bf16 v20, v235, v11, v20
  v_dot2_f32_bf16 v21, v239, v11, v21
  v_dot2_f32_bf16 v20, v240, v12, v20
  v_dot2_f32_bf16 v21, v244, v12, v21
  v_dot2_f32_bf16 v20, v241, v13, v20
  v_dot2_f32_bf16 v21, v245, v13, v21
  v_dot2_f32_bf16 v20, v242, v14, v20
  v_dot2_f32_bf16 v21, v246, v14, v21
  v_dot2_f32_bf16 v20, v243, v15, v20
  v_dot2_f32_bf16 v21, v247, v15, v21
  v_dot2_f32_bf16 v20, v248, v16, v20
  v_dot2_f32_bf16 v21, v252, v16, v21
  v_dot2_f32_bf16 v20, v249, v17, v20
  v_dot2_f32_bf16 v21, v253, v17, v21
  v_dot2_f32_bf16 v20, v250, v18, v20
  v_dot2_f32_bf16 v21, v254, v18, v21
  v_dot2_f32_bf16 v20, v251, v19, v20
  v_dot2_f32_bf16 v21, v255, v19, v21
  s_nop 2
  ds_write_b64 v4, v[20:21] offset:14336
  v_mov_b32 v53, 1
  s_mov_b64 exec, 1
  ds_add_u32 v5, v53 offset:416
  s_mov_b64 exec, -1
  v_bfe_u32 v28, v26, 0, 8
  v_bfe_u32 v29, v26, 8, 8
  v_bfe_u32 v30, v26, 16, 8
  v_bfe_u32 v31, v26, 24, 8
  v_mov_b64 v[192:193], 0
  v_mov_b64 v[194:195], 0
  v_mov_b64 v[196:197], 0
  v_mov_b64 v[198:199], 0
  v_mov_b64 v[200:201], 0
  v_mov_b64 v[202:203], 0
  v_mov_b64 v[204:205], 0
  v_mov_b64 v[206:207], 0
  v_mov_b64 v[208:209], 0
  v_mov_b64 v[210:211], 0
  v_mov_b64 v[212:213], 0
  v_mov_b64 v[214:215], 0
  v_mov_b64 v[216:217], 0
  v_mov_b64 v[218:219], 0
  v_mov_b64 v[220:221], 0
  v_mov_b64 v[222:223], 0
L_soft:
  s_sub_u32 s38, s30, 1
  s_mul_i32 s39, s38, 192
  s_addk_i32 s39, 240
  v_and_b32 v6, 7, v2
  v_lshlrev_b32 v6, 4, v6
  s_lshl_b32 s40, s38, 14
  s_add_u32 s40, s40, 32768
  v_lshl_add_u32 v4, v2, 6, s40
  s_lshl_b32 s40, s38, 11
  v_lshl_add_u32 v7, v2, 3, s40
  s_lshl_b32 s40, s38, 2
  s_nop 0
  v_mov_b32 v24, s40
  s_and_b32 s72, s78, 3
  s_lshl_b32 s40, s3, 2
  s_add_u32 s72, s72, s40
  s_lshl_b32 s72, s72, 2
  s_add_u32 s72, s72, s38
  s_mul_i32 s72, s72, 6272
  s_add_u32 s72, s72, 2523136
  s_lshr_b32 s40, s78, 2
  s_lshl_b32 s40, s40, 4
  s_add_u32 s73, s72, s40
  s_mov_b32 s52, 0x3dd53b95
  s_mov_b32 s70, 0x07060501
  s_mov_b32 s51, 1048576
L_s1:
  ds_read_b32 v53, v5 offset:512
  s_waitcnt lgkmcnt(0)
  v_cmp_gt_u32 vcc, s39, v53
  s_cbranch_vccz L_s1ok
  s_sleep 16
  s_sub_u32 s51, s51, 1
  s_cbranch_scc0 L_s1
L_s1ok:
  s_mov_b32 s51, 1048576
L_s2:
  ds_read_b32 v53, v5 offset:416
  s_waitcnt lgkmcnt(0)
  v_cmp_gt_u32 vcc, 3, v53
  s_cbranch_vccz L_s2ok
  s_sleep 1
  s_sub_u32 s51, s51, 1
  s_cbranch_scc0 L_s2
L_s2ok:
  ds_read_b128 v[64:67], v4 offset:0
  ds_read_b128 v[68:71], v4 offset:16
  ds_read_b128 v[72:75], v4 offset:32
  ds_read_b128 v[76:79], v4 offset:48
  s_waitcnt lgkmcnt(0)
  v_pk_add_f32 v[64:65], v[64:65], v[72:73]
  v_pk_add_f32 v[66:67], v[66:67], v[74:75]
  v_pk_add_f32 v[68:69], v[68:69], v[76:77]
  v_pk_add_f32 v[70:71], v[70:71], v[78:79]
  v_pk_add_f32 v[64:65], v[64:65], v[68:69]
  v_pk_add_f32 v[66:67], v[66:67], v[70:71]
  v_pk_add_f32 v[128:129], v[64:65], v[66:67]
  ds_read_b128 v[80:83], v4 offset:4096
  ds_read_b128 v[84:87], v4 offset:4112
  ds_read_b128 v[88:91], v4 offset:4128
  ds_read_b128 v[92:95], v4 offset:4144
  s_waitcnt lgkmcnt(0)
  v_pk_add_f32 v[80:81], v[80:81], v[88:89]
  v_pk_add_f32 v[82:83], v[82:83], v[90:91]
  v_pk_add_f32 v[84:85], v[84:85], v[92:93]
  v_pk_add_f32 v[86:87], v[86:87], v[94:95]
  v_pk_add_f32 v[80:81], v[80:81], v[84:85]
  v_pk_add_f32 v[82:83], v[82:83], v[86:87]
  v_pk_add_f32 v[130:131], v[80:81], v[82:83]
  ds_read_b128 v[64:67], v4 offset:8192
  ds_read_b128 v[68:71], v4 offset:8208
  ds_read_b128 v[72:75], v4 offset:8224
  ds_read_b128 v[76:79], v4 offset:8240
  s_waitcnt lgkmcnt(0)
  v_pk_add_f32 v[64:65], v[64:65], v[72:73]
  v_pk_add_f32 v[66:67], v[66:67], v[74:75]
  v_pk_add_f32 v[68:69], v[68:69], v[76:77]
  v_pk_add_f32 v[70:71], v[70:71], v[78:79]
  v_pk_add_f32 v[64:65], v[64:65], v[68:69]
  v_pk_add_f32 v[66:67], v[66:67], v[70:71]
  v_pk_add_f32 v[132:133], v[64:65], v[66:67]
  ds_read_b128 v[80:83], v4 offset:12288
  ds_read_b128 v[84:87], v4 offset:12304
  ds_read_b128 v[88:91], v4 offset:12320
  ds_read_b128 v[92:95], v4 offset:12336
  s_waitcnt lgkmcnt(0)
  v_pk_add_f32 v[80:81], v[80:81], v[88:89]
  v_pk_add_f32 v[82:83], v[82:83], v[90:91]
  v_pk_add_f32 v[84:85], v[84:85], v[92:93]
  v_pk_add_f32 v[86:87], v[86:87], v[94:95]
  v_pk_add_f32 v[80:81], v[80:81], v[84:85]
  v_pk_add_f32 v[82:83], v[82:83], v[86:87]
  v_pk_add_f32 v[134:135], v[80:81], v[82:83]
  v_max3_f32 v22, v128, v129, v130
  v_max3_f32 v22, v22, v131, v132
  v_max3_f32 v22, v22, v133, v134
  v_max_f32 v22, v22, v135
  s_nop 1
  v_max_f32_dpp v22, v22, v22 quad_perm:[1,0,3,2] row_mask:0xf bank_mask:0xf
  s_nop 1
  v_max_f32_dpp v22, v22, v22 quad_perm:[2,3,0,1] row_mask:0xf bank_mask:0xf
  s_nop 1
  v_max_f32_dpp v22, v22, v22 row_half_mirror row_mask:0xf bank_mask:0xf
  s_nop 1
  v_max_f32_dpp v22, v22, v22 row_ror:8 row_mask:0xf bank_mask:0xf
  s_nop 0
  v_mov_b32 v52, v22
  s_nop 1
  v_permlane16_swap_b32 v22, v52
  s_nop 1
  v_max_f32 v22, v22, v52
  s_nop 0
  v_mov_b32 v52, v22
  s_nop 1
  v_permlane32_swap_b32 v22, v52
  s_nop 1
  v_max_f32 v22, v22, v52
  v_mul_f32 v22, s52, v22
  v_fma_f32 v128, v128, s52, -v22
  v_fma_f32 v129, v129, s52, -v22
  v_fma_f32 v130, v130, s52, -v22
  v_fma_f32 v131, v131, s52, -v22
  v_fma_f32 v132, v132, s52, -v22
  v_fma_f32 v133, v133, s52, -v22
  v_fma_f32 v134, v134, s52, -v22
  v_fma_f32 v135, v135, s52, -v22
  v_exp_f32 v128, v128
  v_exp_f32 v129, v129
  v_exp_f32 v130, v130
  v_exp_f32 v131, v131
  v_exp_f32 v132, v132
  v_exp_f32 v133, v133
  v_exp_f32 v134, v134
  v_exp_f32 v135, v135
  s_nop 0
  v_add_f32 v23, v128, v129
  v_add_f32 v23, v23, v130
  v_add_f32 v23, v23, v131
  v_add_f32 v23, v23, v132
  v_add_f32 v23, v23, v133
  v_add_f32 v23, v23, v134
  v_add_f32 v23, v23, v135
  s_nop 1
  v_add_f32_dpp v23, v23, v23 quad_perm:[1,0,3,2] row_mask:0xf bank_mask:0xf
  s_nop 1
  v_add_f32_dpp v23, v23, v23 quad_perm:[2,3,0,1] row_mask:0xf bank_mask:0xf
  s_nop 1
  v_add_f32_dpp v23, v23, v23 row_half_mirror row_mask:0xf bank_mask:0xf
  s_nop 1
  v_add_f32_dpp v23, v23, v23 row_ror:8 row_mask:0xf bank_mask:0xf
  s_nop 0
  v_mov_b32 v52, v23
  s_nop 1
  v_permlane16_swap_b32 v23, v52
  s_nop 1
  v_add_f32 v23, v23, v52
  s_nop 0
  v_mov_b32 v52, v23
  s_nop 1
  v_permlane32_swap_b32 v23, v52
  s_nop 1
  v_add_f32 v23, v23, v52
  s_mov_b32 s51, 1048576
L_s3:
  ds_read_b32 v53, v5 offset:412
  s_waitcnt lgkmcnt(0)
  v_cmp_gt_u32 vcc, 1, v53
  s_cbranch_vccz L_s3ok
  s_sleep 8
  s_sub_u32 s51, s51, 1
  s_cbranch_scc0 L_s3
L_s3ok:
  v_bfi_b32 v64, s77, v26, v22
  v_bfi_b32 v65, s77, v26, v23
  v_lshl_or_b32 v66, v22, 8, v27
  v_mov_b32 v67, v26
  v_cmp_ne_u32 vcc, 1, v53
  s_mov_b64 exec, 1
  s_cbranch_vccnz L_mlf
  buffer_store_dwordx4 v[64:67], v5, s[64:67], s73 offen
  s_branch L_mld
L_mlf:
  buffer_store_dwordx4 v[64:67], v5, s[64:67], s73 offen sc1
L_mld:
  s_mov_b64 exec, -1
  s_mov_b32 s51, 1048576
L_s4:
  ds_read_b32 v53, v5 offset:420
  s_waitcnt lgkmcnt(0)
  v_cmp_gt_u32 vcc, 1, v53
  s_cbranch_vccz L_s4ok
  s_sleep 8
  s_sub_u32 s51, s51, 1
  s_cbranch_scc0 L_s4
L_s4ok:
  ds_read_b32 v24, v24 offset:384
  s_mov_b32 s51, 1048576
L_pm:
  s_cmp_lt_u32 s51, 1048564
  s_cbranch_scc1 L_pms
  buffer_load_dwordx4 v[68:71], v6, s[64:67], s72 offen nt
  s_branch L_pmd
L_pms:
  buffer_load_dwordx4 v[68:71], v6, s[64:67], s72 offen sc1
L_pmd:
  s_waitcnt vmcnt(0) lgkmcnt(0)
  v_xor_b32 v21, v26, v71
  v_perm_b32 v71, v68, v70, s70
  v_xor_b32 v69, v27, v69
  v_bitop3_b32 v20, v68, v70, v27 bitop3:0x7e
  v_bitop3_b32 v20, v20, v69, s77 bitop3:0xa8
  v_or_b32 v20, v20, v21
  v_cmp_ne_u32 vcc, 0, v20
  s_cbranch_vccz L_gm
  s_sleep 16
  s_sub_u32 s51, s51, 1
  s_cbranch_scc0 L_pm
L_gm:
  v_mov_b32 v52, v71
  s_nop 1
  v_max_f32_dpp v52, v52, v52 quad_perm:[1,0,3,2] row_mask:0xf bank_mask:0xf
  s_nop 1
  v_max_f32_dpp v52, v52, v52 quad_perm:[2,3,0,1] row_mask:0xf bank_mask:0xf
  s_nop 1
  v_max_f32_dpp v52, v52, v52 row_half_mirror row_mask:0xf bank_mask:0xf
  v_sub_f32 v53, v71, v52
  v_sub_f32 v54, v22, v52
  v_exp_f32 v53, v53
  v_exp_f32 v54, v54
  v_mul_f32 v53, v53, v69
  v_mul_f32 v54, v54, v24
  s_nop 1
  v_add_f32_dpp v53, v53, v53 quad_perm:[1,0,3,2] row_mask:0xf bank_mask:0xf
  s_nop 1
  v_add_f32_dpp v53, v53, v53 quad_perm:[2,3,0,1] row_mask:0xf bank_mask:0xf
  s_nop 1
  v_add_f32_dpp v53, v53, v53 row_half_mirror row_mask:0xf bank_mask:0xf
  v_rcp_f32 v53, v53
  s_nop 0
  v_mul_f32 v54, v54, v53
  v_mul_f32 v128, v128, v54
  v_mul_f32 v129, v129, v54
  v_mul_f32 v130, v130, v54
  v_mul_f32 v131, v131, v54
  v_mul_f32 v132, v132, v54
  v_mul_f32 v133, v133, v54
  v_mul_f32 v134, v134, v54
  v_mul_f32 v135, v135, v54
  v_cvt_pk_bf16_f32 v128, v128, v128
  v_cvt_pk_bf16_f32 v129, v129, v129
  v_cvt_pk_bf16_f32 v130, v130, v130
  v_cvt_pk_bf16_f32 v131, v131, v131
  v_cvt_pk_bf16_f32 v132, v132, v132
  v_cvt_pk_bf16_f32 v133, v133, v133
  v_cvt_pk_bf16_f32 v134, v134, v134
  v_cvt_pk_bf16_f32 v135, v135, v135
  ds_write_b64 v7, v[128:129] offset:12288
  ds_write_b64 v7, v[130:131] offset:12800
  ds_write_b64 v7, v[132:133] offset:13312
  ds_write_b64 v7, v[134:135] offset:13824
  s_and_b32 s40, s30, 4
  v_mov_b32 v52, s40
  v_mov_b32 v53, 1
  s_mov_b64 exec, 1
  ds_add_u32 v52, v53 offset:424
  s_mov_b64 exec, -1
L_stage2:
  v_lshlrev_b32 v9, 4, v2
  s_sub_u32 s40, s2, 176
  s_mul_i32 s75, s40, 6272
  s_add_u32 s75, s75, 3319808
  s_add_u32 s76, s75, 3072
  s_lshl_b32 s69, s40, 4
  s_mov_b32 s96, s24
  s_mov_b32 s97, s25
  s_mov_b32 s98, 5120
  s_mov_b32 s99, 0x20000
  v_lshrrev_b32 v16, 4, v2
  v_mul_u32_u24 v17, 10240, v16
  v_mul_u32_u24 v16, 1280, v16
  v_lshrrev_b32 v52, 3, v6
  v_add_u32 v16, v16, v52
  s_and_b32 s41, s30, 4
  v_lshrrev_b32 v18, 2, v2
  v_and_b32 v52, 3, v2
  v_lshlrev_b32 v18, 7, v18
  v_lshl_add_u32 v18, v52, 4, v18
  s_lshl_b32 s42, s41, 4
  s_add_u32 s75, s75, s42
  s_add_u32 s76, s75, 4096
  s_lshl_b32 s41, s41, 1
  s_add_u32 s69, s69, s41
  s_cmp_ge_u32 s78, 30
  s_cbranch_scc1 L_light
  s_and_b32 s49, s30, 3
  s_lshl_b32 s48, s56, 2
  s_add_u32 s48, s48, s49
  v_and_b32 v7, 15, v2
  v_lshl_add_u32 v17, v7, 4, v17
  s_mul_i32 s53, s3, 24
  s_add_u32 s53, s53, s48
  s_mul_i32 s53, s53, 40960
  s_lshl_b32 s40, s57, 8
  s_add_u32 s53, s53, s40
  s_mov_b32 s60, s12
  s_mov_b32 s61, s13
  s_mov_b32 s62, 7864320
  s_mov_b32 s63, 0x20000
  s_lshl_b32 s42, s3, 2
  s_mul_i32 s40, s48, 43691
  s_lshr_b32 s40, s40, 18
  s_mul_i32 s73, s40, 6
  s_sub_u32 s73, s48, s73
  s_add_u32 s40, s40, s42
  s_mul_i32 s40, s40, 25088
  s_add_u32 s40, s40, 2516992
  s_lshl_b32 s73, s73, 10
  s_add_u32 s73, s73, s40
  s_mov_b32 s36, 0xfffefffe
  s_mov_b32 s37, s36
  s_mov_b32 s38, 0
  v_mul_u32_u24 v13, 144, v2
  s_mul_i32 s40, s49, 2304
  v_add_u32 v13, s40, v13
  v_subrev_u32 v52, 64, v0
  v_lshrrev_b32 v15, 3, v52
  v_add_u32 v14, v15, v52
  v_lshlrev_b32 v14, 4, v14
  v_mul_u32_u24 v15, 6272, v15
  v_add_u32 v15, v15, v6
  s_mul_i32 s74, s3, 6
  s_add_u32 s74, s74, s56
  s_lshl_b32 s74, s74, 7
  s_mul_i32 s40, s57, 100352
  s_add_u32 s74, s74, s40
  s_add_u32 s74, s74, 3319808
  s_cmp_lg_u32 s57, 0
  s_cbranch_scc1 L_not
  v_bfe_u32 v52, v2, 3, 2
  v_mul_u32_u24 v52, 6272, v52
  v_lshl_add_u32 v52, v6, 3, v52
  s_mov_b32 exec_hi, 0
  buffer_load_dword v54, v52, s[64:67], s73 offen sc1
  s_mov_b64 exec, -1
L_not:
  s_mov_b32 s51, 1048576
L_w1:
  ds_read_b32 v53, v5 offset:512
  s_waitcnt lgkmcnt(0)
  v_cmp_gt_u32 vcc, 1300, v53
  s_cbranch_vccz L_w1ok
  s_sleep 16
  s_sub_u32 s51, s51, 1
  s_cbranch_scc0 L_w1
L_w1ok:
L_bat:
  s_cmp_eq_u32 s38, 3
  s_cbranch_scc1 L_wo
  buffer_load_dwordx4 v[128:131], v9, s[64:67], s73 offen nt
  s_branch L_p0
L_wo:
  s_mov_b32 s51, 1048576
L_w2:
  ds_read_b32 v53, v5 offset:512
  s_waitcnt lgkmcnt(0)
  v_cmp_gt_u32 vcc, 1536, v53
  s_cbranch_vccz L_w2ok
  s_sleep 1
  s_sub_u32 s51, s51, 1
  s_cbranch_scc0 L_w2
L_w2ok:
  buffer_load_dwordx4 v[64:67], v17, s[60:63], s53 offen offset:0 nt
  buffer_load_dwordx4 v[68:71], v17, s[60:63], s53 offen offset:1280 nt
  s_mov_b32 s51, 1048576
L_ws0:
  ds_read_b32 v53, v5 offset:512
  s_waitcnt lgkmcnt(0)
  v_cmp_gt_u32 vcc, 1537, v53
  s_cbranch_vccz L_ws0ok
  s_sub_u32 s51, s51, 1
  s_cbranch_scc0 L_ws0
L_ws0ok:
  buffer_load_dwordx4 v[72:75], v17, s[60:63], s53 offen offset:2560 nt
  s_add_u32 s53, s53, 3840
  s_mov_b32 s51, 1048576
L_ws1:
  ds_read_b32 v53, v5 offset:512
  s_waitcnt lgkmcnt(0)
  v_cmp_gt_u32 vcc, 1538, v53
  s_cbranch_vccz L_ws1ok
  s_sub_u32 s51, s51, 1
  s_cbranch_scc0 L_ws1
L_ws1ok:
  buffer_load_dwordx4 v[76:79], v17, s[60:63], s53 offen offset:0 nt
  s_mov_b32 s51, 1048576
L_ws2:
  ds_read_b32 v53, v5 offset:512
  s_waitcnt lgkmcnt(0)
  v_cmp_gt_u32 vcc, 1539, v53
  s_cbranch_vccz L_ws2ok
  s_sub_u32 s51, s51, 1
  s_cbranch_scc0 L_ws2
L_ws2ok:
  buffer_load_dwordx4 v[80:83], v17, s[60:63], s53 offen offset:1280 nt
  s_waitcnt vmcnt(4)
  buffer_load_dwordx4 v[84:87], v17, s[60:63], s53 offen offset:2560 nt
  s_add_u32 s53, s53, 3840
  s_waitcnt vmcnt(4)
  buffer_load_dwordx4 v[88:91], v17, s[60:63], s53 offen offset:0 nt
  s_waitcnt vmcnt(4)
  buffer_load_dwordx4 v[92:95], v17, s[60:63], s53 offen offset:1280 nt
  s_waitcnt vmcnt(6)
  v_perm_b32 v96, v68, v64, s58
  v_perm_b32 v100, v68, v64, s59
  v_perm_b32 v104, v69, v65, s58
  v_perm_b32 v108, v69, v65, s59
  v_perm_b32 v112, v70, v66, s58
  v_perm_b32 v116, v70, v66, s59
  v_perm_b32 v120, v71, v67, s58
  v_perm_b32 v124, v71, v67, s59
  s_waitcnt vmcnt(4)
  v_perm_b32 v97, v76, v72, s58
  v_perm_b32 v101, v76, v72, s59
  v_perm_b32 v105, v77, v73, s58
  v_perm_b32 v109, v77, v73, s59
  v_perm_b32 v113, v78, v74, s58
  v_perm_b32 v117, v78, v74, s59
  v_perm_b32 v121, v79, v75, s58
  v_perm_b32 v125, v79, v75, s59
  s_waitcnt vmcnt(2)
  v_perm_b32 v98, v84, v80, s58
  v_perm_b32 v102, v84, v80, s59
  v_perm_b32 v106, v85, v81, s58
  v_perm_b32 v110, v85, v81, s59
  v_perm_b32 v114, v86, v82, s58
  v_perm_b32 v118, v86, v82, s59
  v_perm_b32 v122, v87, v83, s58
  v_perm_b32 v126, v87, v83, s59
  s_waitcnt vmcnt(1)
  buffer_load_dwordx4 v[128:131], v9, s[64:67], s73 offen nt
  s_waitcnt vmcnt(1)
  v_perm_b32 v99, v92, v88, s58
  v_perm_b32 v103, v92, v88, s59
  v_perm_b32 v107, v93, v89, s58
  v_perm_b32 v111, v93, v89, s59
  v_perm_b32 v115, v94, v90, s58
  v_perm_b32 v119, v94, v90, s59
  v_perm_b32 v123, v95, v91, s58
  v_perm_b32 v127, v95, v91, s59
L_p0:
  s_mov_b32 s51, 1048576
L_poll1:
  s_waitcnt vmcnt(0)
  v_xor_b32 v128, v28, v128
  v_xor_b32 v129, v29, v129
  v_xor_b32 v130, v30, v130
  v_xor_b32 v131, v31, v131
  v_or3_b32 v20, v128, v129, v130
  v_bitop3_b32 v20, v20, v131, s77 bitop3:0xa8
  v_cmp_ne_u32 vcc, 0, v20
  s_cbranch_vccnz L_retry1
L_got1:
  v_add_f32_dpp v128, v128, v128 quad_perm:[1,0,3,2] row_mask:0xf bank_mask:0xf
  v_add_f32_dpp v129, v129, v129 quad_perm:[1,0,3,2] row_mask:0xf bank_mask:0xf
  v_add_f32_dpp v130, v130, v130 quad_perm:[1,0,3,2] row_mask:0xf bank_mask:0xf
  v_add_f32_dpp v131, v131, v131 quad_perm:[1,0,3,2] row_mask:0xf bank_mask:0xf
  v_add_f32_dpp v128, v128, v128 quad_perm:[2,3,0,1] row_mask:0xf bank_mask:0xf
  v_add_f32_dpp v129, v129, v129 quad_perm:[2,3,0,1] row_mask:0xf bank_mask:0xf
  v_add_f32_dpp v130, v130, v130 quad_perm:[2,3,0,1] row_mask:0xf bank_mask:0xf
  v_add_f32_dpp v131, v131, v131 quad_perm:[2,3,0,1] row_mask:0xf bank_mask:0xf
  v_add_f32_dpp v128, v128, v128 row_half_mirror row_mask:0xf bank_mask:0xf
  v_add_f32_dpp v129, v129, v129 row_half_mirror row_mask:0xf bank_mask:0xf
  v_add_f32_dpp v130, v130, v130 row_half_mirror row_mask:0xf bank_mask:0xf
  v_add_f32_dpp v131, v131, v131 row_half_mirror row_mask:0xf bank_mask:0xf
  v_cvt_pk_bf16_f32 v128, v128, v129
  v_cvt_pk_bf16_f32 v129, v130, v131
  s_mov_b64 vcc, s[36:37]
  v_cndmask_b32 v140, v128, v140, vcc
  v_cndmask_b32 v141, v129, v141, vcc
  v_cndmask_b32_dpp v142, v128, v142, vcc row_ror:8 row_mask:0xf bank_mask:0xf
  v_cndmask_b32_dpp v143, v129, v143, vcc row_ror:8 row_mask:0xf bank_mask:0xf
  s_cmp_lg_u32 s38, 3
  s_cbranch_scc1 L_nb
  v_mfma_f32_16x16x32_bf16 v[192:195], v[140:143], v[96:99], v[192:195]
  s_nop 2
  v_mfma_f32_16x16x32_bf16 v[196:199], v[140:143], v[100:103], v[196:199]
  s_nop 2
  v_mfma_f32_16x16x32_bf16 v[200:203], v[140:143], v[104:107], v[200:203]
  s_mov_b64 exec, 0xffff
  ds_write_b128 v13, v[192:195] offset:3072
  s_mov_b64 exec, -1
  v_mfma_f32_16x16x32_bf16 v[204:207], v[140:143], v[108:111], v[204:207]
  s_mov_b64 exec, 0xffff
  ds_write_b128 v13, v[196:199] offset:3088
  s_mov_b64 exec, -1
  v_mfma_f32_16x16x32_bf16 v[208:211], v[140:143], v[112:115], v[208:211]
  s_mov_b64 exec, 0xffff
  ds_write_b128 v13, v[200:203] offset:3104
  s_mov_b64 exec, -1
  v_mfma_f32_16x16x32_bf16 v[212:215], v[140:143], v[116:119], v[212:215]
  s_mov_b64 exec, 0xffff
  ds_write_b128 v13, v[204:207] offset:3120
  s_mov_b64 exec, -1
  v_mfma_f32_16x16x32_bf16 v[216:219], v[140:143], v[120:123], v[216:219]
  s_mov_b64 exec, 0xffff
  ds_write_b128 v13, v[208:211] offset:3136
  s_mov_b64 exec, -1
  v_mfma_f32_16x16x32_bf16 v[220:223], v[140:143], v[124:127], v[220:223]
  s_mov_b64 exec, 0xffff
  ds_write_b128 v13, v[212:215] offset:3152
  s_mov_b64 exec, -1
  s_mov_b64 exec, 0xffff
  ds_write_b128 v13, v[216:219] offset:3168
  s_nop 1
  s_mov_b64 exec, 0xffff
  ds_write_b128 v13, v[220:223] offset:3184
  s_mov_b64 exec, -1
  s_waitcnt lgkmcnt(0)
  s_barrier
  s_cmp_ge_u32 s30, 3
  s_cbranch_scc1 L_final
  ds_read_b128 v[144:147], v14 offset:3072
  ds_read_b128 v[148:151], v14 offset:5376
  ds_read_b128 v[152:155], v14 offset:7680
  ds_read_b128 v[156:159], v14 offset:9984
  s_waitcnt lgkmcnt(2)
  v_pk_add_f32 v[144:145], v[144:145], v[148:149]
  v_pk_add_f32 v[146:147], v[146:147], v[150:151]
  s_waitcnt lgkmcnt(1)
  v_pk_add_f32 v[144:145], v[144:145], v[152:153]
  v_pk_add_f32 v[146:147], v[146:147], v[154:155]
  s_waitcnt lgkmcnt(0)
  v_pk_add_f32 v[144:145], v[144:145], v[156:157]
  v_pk_add_f32 v[146:147], v[146:147], v[158:159]
  v_bfi_b32 v144, s77, v28, v144
  v_bfi_b32 v145, s77, v29, v145
  v_bfi_b32 v146, s77, v30, v146
  v_bfi_b32 v147, s77, v31, v147
  buffer_store_dwordx4 v[144:147], v15, s[64:67], s74 offen sc1
  s_endpgm
L_retry1:
  s_sub_u32 s51, s51, 1
  s_cbranch_scc1 L_got1
  s_and_b32 s40, s51, 31
  s_cbranch_scc0 L_poll1s
  buffer_load_dwordx4 v[128:131], v9, s[64:67], s73 offen nt
  s_branch L_poll1
L_poll1s:
  buffer_load_dwordx4 v[128:131], v9, s[64:67], s73 offen sc1
  s_branch L_poll1
L_nb:
  s_add_u32 s38, s38, 1
  s_add_u32 s73, s73, 6272
  s_lshl_b32 s36, s36, 1
  s_or_b32 s36, s36, 1
  s_mov_b32 s37, s36
  s_mul_i32 s39, s38, 90
  s_add_u32 s39, s39, 1300
  s_min_u32 s39, s39, 1500
  s_mov_b32 s51, 1048576
L_w3:
  ds_read_b32 v53, v5 offset:512
  s_waitcnt lgkmcnt(0)
  v_cmp_gt_u32 vcc, s39, v53
  s_cbranch_vccz L_w3ok
  s_sleep 8
  s_sub_u32 s51, s51, 1
  s_cbranch_scc0 L_w3
L_w3ok:
  s_branch L_bat
L_light:
  s_barrier
L_final:
  s_cmp_lt_u32 s30, 3
  s_cbranch_scc1 L_end
  s_cmp_lt_u32 s2, 176
  s_cbranch_scc1 L_end
  s_mov_b32 s51, 1048576
L_y0r:
  buffer_load_dwordx4 v[64:67], v18, s[64:67], s75 offen offset:0 sc1
  buffer_load_dwordx4 v[68:71], v18, s[64:67], s75 offen offset:2048 sc1
  buffer_load_dwordx4 v[72:75], v18, s[64:67], s76 offen offset:0 sc1
L_y0:
  s_waitcnt vmcnt(2)
  v_xor_b32 v64, v28, v64
  v_xor_b32 v65, v29, v65
  v_xor_b32 v66, v30, v66
  v_xor_b32 v67, v31, v67
  v_or3_b32 v53, v64, v65, v66
  v_bitop3_b32 v53, v53, v67, s77 bitop3:0xa8
  v_cmp_ne_u32 vcc, 0, v53
  s_cbranch_vccnz L_y0x
L_y0k:
L_y1:
  s_waitcnt vmcnt(1)
  v_xor_b32 v68, v28, v68
  v_xor_b32 v69, v29, v69
  v_xor_b32 v70, v30, v70
  v_xor_b32 v71, v31, v71
  v_or3_b32 v53, v68, v69, v70
  v_bitop3_b32 v53, v53, v71, s77 bitop3:0xa8
  v_cmp_ne_u32 vcc, 0, v53
  s_cbranch_vccnz L_y1x
L_y1k:
  v_pk_add_f32 v[64:65], v[64:65], v[68:69]
  v_pk_add_f32 v[66:67], v[66:67], v[70:71]
L_y2:
  s_waitcnt vmcnt(0)
  v_xor_b32 v72, v28, v72
  v_xor_b32 v73, v29, v73
  v_xor_b32 v74, v30, v74
  v_xor_b32 v75, v31, v75
  v_or3_b32 v53, v72, v73, v74
  v_bitop3_b32 v53, v53, v75, s77 bitop3:0xa8
  v_cmp_ne_u32 vcc, 0, v53
  s_cbranch_vccnz L_y2x
L_y2k:
  v_pk_add_f32 v[64:65], v[64:65], v[72:73]
  v_pk_add_f32 v[66:67], v[66:67], v[74:75]
  s_nop 0
L_ysum:
  s_nop 0
  v_permlane32_swap_b32 v64, v66
  v_permlane32_swap_b32 v65, v67
  v_add_f32 v112, v64, v66
  v_add_f32 v113, v65, v67
  s_nop 1
  v_permlane16_swap_b32 v112, v113
  v_add_f32 v112, v112, v113
  s_nop 1
  v_add_f32_dpp v112, v112, v112 row_ror:8 row_mask:0xf bank_mask:0xf
  s_nop 1
  v_add_f32_dpp v112, v112, v112 row_ror:4 row_mask:0xf bank_mask:0xf
  s_mov_b32 exec_lo, 0x000f000f
  s_mov_b32 exec_hi, 0x000f000f
  v_cvt_pk_bf16_f32 v112, v112, v112
  buffer_store_short v112, v16, s[96:99], s69 offen
  s_cmp_lg_u32 s2, 176
  s_cbranch_scc1 L_nobump
  s_mov_b64 exec, 1
  buffer_store_dword v26, v5, s[64:67], 0 offen offset:0
L_nobump:
  s_endpgm
L_y0x:
  s_sub_u32 s51, s51, 1
  s_cselect_b32 s51, 0, s51
  s_cbranch_scc1 L_y0k
  s_branch L_y0r
L_y1x:
  s_sub_u32 s51, s51, 1
  s_cselect_b32 s51, 0, s51
  s_cbranch_scc1 L_y1k
  buffer_load_dwordx4 v[68:71], v18, s[64:67], s75 offen offset:2048 sc1
  buffer_load_dwordx4 v[72:75], v18, s[64:67], s76 offen offset:0 sc1
  s_branch L_y1
L_y2x:
  s_sub_u32 s51, s51, 1
  s_cselect_b32 s51, 0, s51
  s_cbranch_scc1 L_y2k
  buffer_load_dwordx4 v[72:75], v18, s[64:67], s76 offen offset:0 sc1
  s_branch L_y2
L_aux:
  s_load_dwordx8 s[16:23], s[0:1], 48
  s_load_dwordx2 s[12:13], s[0:1], 32
  s_load_dwordx2 s[24:25], s[0:1], 80
  s_load_dwordx2 s[28:29], s[0:1], 96
  v_mov_b32 v5, 0
  s_cmp_eq_u32 s30, 4
  s_cbranch_scc1 L_helper
  v_lshlrev_b32 v6, 2, v2
  ds_write_b32 v6, v5 offset:384
  v_mov_b32 v12, 84
  ds_write_b32 v5, v12 offset:400
  s_getpc_b64 s[40:41]
L_pc:
  s_sub_u32 s40, s40, L_pc-gated_mix__mha_block_cached__geglu_ffn__decode_kernel
  s_subb_u32 s41, s41, 0
  s_lshl_b32 s42, s78, 3
  v_and_b32 v8, 7, v2
  v_add_u32 v8, s42, v8
  v_lshlrev_b32 v8, 7, v8
  v_min_u32 v8, L_end-gated_mix__mha_block_cached__geglu_ffn__decode_kernel, v8
  v_mov_b32 v9, s41
  v_add_co_u32 v8, vcc, s40, v8
  s_mov_b64 exec, 0xff
  s_nop 0
  v_addc_co_u32 v9, vcc, 0, v9, vcc
  global_load_dword v10, v[8:9], off
  s_mov_b64 exec, -1
  s_waitcnt lgkmcnt(0)
  s_barrier
  s_mov_b32 s64, s28
  s_mov_b32 s65, s29
  s_mov_b32 s66, 3821568
  s_mov_b32 s67, 0x20000
  s_load_dword s55, s[28:29], 0
  s_mul_i32 s40, s3, 4352
  s_add_u32 s40, s40, 1744896
  s_lshl_b32 s41, s78, 2
  s_add_u32 s41, s41, s40
  s_add_u32 s62, s40, 128
  s_mul_i32 s42, s3, 4352
  s_add_u32 s42, s42, 4096
  v_min_u32 v6, 32, v2
  v_lshlrev_b32 v6, 2, v6
  v_mov_b32 v14, 0
  s_mov_b32 s49, 0
  s_mov_b32 s51, 1048576
L_fs:
  ds_read_b32 v13, v5 offset:512
  s_waitcnt lgkmcnt(0)
  v_cmp_gt_u32 vcc, 200, v13
  s_cbranch_vccz L_fsok
  s_sleep 8
  s_sub_u32 s51, s51, 1
  s_cbranch_scc0 L_fs
L_fsok:
  s_add_u32 s55, s55, 2654435769
  s_mov_b32 s51, 1048576
  v_mov_b32 v19, s55
  s_mov_b32 s16, 256
  s_mov_b32 s32, 40
  s_mov_b32 s17, 256
  s_mov_b32 s33, 40
  s_mov_b32 s18, 256
  s_mov_b32 s34, 40
  s_mov_b32 s19, 256
  s_mov_b32 s35, 40
  s_mov_b32 s20, 256
  s_mov_b32 s36, 40
  s_mov_b32 s21, 256
  s_mov_b32 s37, 40
  s_mov_b32 s22, 256
  s_mov_b32 s38, 40
  s_mov_b32 s23, 256
  s_mov_b32 s39, 40
  s_mov_b32 s50, 256
  s_mov_b32 s52, 0
  s_mov_b32 s53, 0
  s_mov_b32 s25, 0
  s_mov_b32 s45, 0
L_fcl:
  buffer_load_dword v20, v6, s[64:67], s40 offen nt
  ds_read_b32 v24, v5 offset:512
  s_waitcnt lgkmcnt(0)
  v_cmp_gt_u32 vcc, 1505, v24
  s_cbranch_vccz L_fcx
  v_add_u32 v17, s55, v24
  s_mov_b64 exec, 1
  buffer_store_dword v17, v5, s[64:67], s41 offen
  s_mov_b64 exec, -1
  s_cmp_lg_u32 s78, 5
  s_cbranch_scc1 L_f1
  s_sub_u32 s8, s55, 1
  s_add_i32 s46, s16, s32
  s_sub_i32 s46, s46, 50
  s_cmp_lt_i32 s45, s46
  s_cbranch_scc1 L_xr0
  s_mul_i32 s46, s16, 272
  s_load_dword s8, s[28:29], s46 offset:4096 glc
L_xr0:
  s_sub_u32 s9, s55, 1
  s_add_i32 s46, s17, s33
  s_sub_i32 s46, s46, 50
  s_cmp_lt_i32 s45, s46
  s_cbranch_scc1 L_xr1
  s_mul_i32 s46, s17, 272
  s_load_dword s9, s[28:29], s46 offset:8448 glc
L_xr1:
  s_sub_u32 s10, s55, 1
  s_add_i32 s46, s18, s34
  s_sub_i32 s46, s46, 50
  s_cmp_lt_i32 s45, s46
  s_cbranch_scc1 L_xr2
  s_mul_i32 s46, s18, 272
  s_load_dword s10, s[28:29], s46 offset:12800 glc
L_xr2:
  s_sub_u32 s11, s55, 1
  s_add_i32 s46, s19, s35
  s_sub_i32 s46, s46, 50
  s_cmp_lt_i32 s45, s46
  s_cbranch_scc1 L_xr3
  s_mul_i32 s46, s19, 272
  s_load_dword s11, s[28:29], s46 offset:17152 glc
L_xr3:
  s_sub_u32 s12, s55, 1
  s_add_i32 s46, s20, s36
  s_sub_i32 s46, s46, 50
  s_cmp_lt_i32 s45, s46
  s_cbranch_scc1 L_xr4
  s_mul_i32 s46, s20, 272
  s_load_dword s12, s[28:29], s46 offset:21504 glc
L_xr4:
  s_sub_u32 s13, s55, 1
  s_add_i32 s46, s21, s37
  s_sub_i32 s46, s46, 50
  s_cmp_lt_i32 s45, s46
  s_cbranch_scc1 L_xr5
  s_mul_i32 s46, s21, 272
  s_load_dword s13, s[28:29], s46 offset:25856 glc
L_xr5:
  s_sub_u32 s14, s55, 1
  s_add_i32 s46, s22, s38
  s_sub_i32 s46, s46, 50
  s_cmp_lt_i32 s45, s46
  s_cbranch_scc1 L_xr6
  s_mul_i32 s46, s22, 272
  s_load_dword s14, s[28:29], s46 offset:30208 glc
L_xr6:
  s_sub_u32 s15, s55, 1
  s_add_i32 s46, s23, s39
  s_sub_i32 s46, s46, 50
  s_cmp_lt_i32 s45, s46
  s_cbranch_scc1 L_xr7
  s_mul_i32 s46, s23, 272
  s_load_dword s15, s[28:29], s46 offset:34560 glc
L_xr7:
L_f1:
  s_waitcnt vmcnt(1)
  v_subrev_u32 v14, s55, v20
  v_cmp_gt_u32 vcc, 2048, v14
  v_subrev_u32 v13, 13, v24
  v_readlane_b32 s43, v14, 32
  v_cndmask_b32 v14, v13, v14, vcc
  v_readfirstlane_b32 s44, v24
  s_nop 0
  v_add_u32_dpp v14, v14, v14 quad_perm:[1,0,3,2] row_mask:0xf bank_mask:0xf
  s_nop 1
  v_add_u32_dpp v14, v14, v14 quad_perm:[2,3,0,1] row_mask:0xf bank_mask:0xf
  s_nop 1
  v_add_u32_dpp v14, v14, v14 row_half_mirror row_mask:0xf bank_mask:0xf
  s_nop 1
  v_add_u32_dpp v14, v14, v14 row_mirror row_mask:0xf bank_mask:0xf
  s_nop 1
  v_readlane_b32 s45, v14, 0
  v_readlane_b32 s46, v14, 16
  s_cmp_lt_u32 s43, 2048
  s_cselect_b32 s43, s43, 1024
  s_add_u32 s45, s45, s46
  s_add_u32 s45, s45, 16
  s_lshr_b32 s45, s45, 5
  s_sub_u32 s44, s44, s45
  s_add_u32 s44, s44, s43
  s_sub_u32 s44, s44, 1037
  s_mul_i32 s46, s44, 11
  s_add_i32 s46, s46, 16
  s_ashr_i32 s46, s46, 5
  s_add_i32 s46, s46, 9
  s_max_i32 s46, s46, 0
  s_min_i32 s46, s46, 18
  s_lshr_b32 s63, s46, 1
  s_add_u32 s47, s46, 1
  s_lshr_b32 s47, s47, 1
  s_lshl_b32 s47, s47, 4
  s_or_b32 s63, s63, s47
  v_mov_b32 v12, s63
  ds_write_b32 v5, v12 offset:400
  s_cmp_lg_u32 s78, 5
  s_cbranch_scc1 L_f2
  s_cmp_lt_u32 s45, s50
  s_cbranch_scc1 L_f4
  s_sub_u32 s46, s45, s50
  s_min_u32 s46, s46, 255
  s_add_u32 s46, s46, s55
  v_mov_b32 v19, s46
  s_mul_i32 s46, s50, 272
  s_add_u32 s46, s46, s42
  s_mov_b32 exec_hi, 0
  buffer_store_dword v19, v6, s[64:67], s46 offen sc1
  s_add_u32 s50, s50, 128
L_f4:
  s_waitcnt lgkmcnt(0)
  s_mov_b32 s47, 0
  s_mov_b32 s24, -1000
  s_sub_i32 s46, s45, s16
  s_sub_i32 s48, s46, 12
  s_max_i32 s48, s32, s48
  s_sub_u32 s8, s8, s55
  s_sub_i32 s46, s46, s8
  s_cmp_lt_u32 s8, 256
  s_cselect_b32 s32, s46, s48
  s_cselect_b32 s46, 128, 0
  s_add_u32 s16, s16, s46
  s_add_i32 s47, s47, s32
  s_max_i32 s24, s24, s32
  s_cmp_eq_u32 s3, 0
  s_cselect_b32 s53, s32, s53
  s_sub_i32 s46, s45, s17
  s_sub_i32 s48, s46, 12
  s_max_i32 s48, s33, s48
  s_sub_u32 s9, s9, s55
  s_sub_i32 s46, s46, s9
  s_cmp_lt_u32 s9, 256
  s_cselect_b32 s33, s46, s48
  s_cselect_b32 s46, 128, 0
  s_add_u32 s17, s17, s46
  s_add_i32 s47, s47, s33
  s_max_i32 s24, s24, s33
  s_cmp_eq_u32 s3, 1
  s_cselect_b32 s53, s33, s53
  s_sub_i32 s46, s45, s18
  s_sub_i32 s48, s46, 12
  s_max_i32 s48, s34, s48
  s_sub_u32 s10, s10, s55
  s_sub_i32 s46, s46, s10
  s_cmp_lt_u32 s10, 256
  s_cselect_b32 s34, s46, s48
  s_cselect_b32 s46, 128, 0
  s_add_u32 s18, s18, s46
  s_add_i32 s47, s47, s34
  s_max_i32 s24, s24, s34
  s_cmp_eq_u32 s3, 2
  s_cselect_b32 s53, s34, s53
  s_sub_i32 s46, s45, s19
  s_sub_i32 s48, s46, 12
  s_max_i32 s48, s35, s48
  s_sub_u32 s11, s11, s55
  s_sub_i32 s46, s46, s11
  s_cmp_lt_u32 s11, 256
  s_cselect_b32 s35, s46, s48
  s_cselect_b32 s46, 128, 0
  s_add_u32 s19, s19, s46
  s_add_i32 s47, s47, s35
  s_max_i32 s24, s24, s35
  s_cmp_eq_u32 s3, 3
  s_cselect_b32 s53, s35, s53
  s_sub_i32 s46, s45, s20
  s_sub_i32 s48, s46, 12
  s_max_i32 s48, s36, s48
  s_sub_u32 s12, s12, s55
  s_sub_i32 s46, s46, s12
  s_cmp_lt_u32 s12, 256
  s_cselect_b32 s36, s46, s48
  s_cselect_b32 s46, 128, 0
  s_add_u32 s20, s20, s46
  s_add_i32 s47, s47, s36
  s_max_i32 s24, s24, s36
  s_cmp_eq_u32 s3, 4
  s_cselect_b32 s53, s36, s53
  s_sub_i32 s46, s45, s21
  s_sub_i32 s48, s46, 12
  s_max_i32 s48, s37, s48
  s_sub_u32 s13, s13, s55
  s_sub_i32 s46, s46, s13
  s_cmp_lt_u32 s13, 256
  s_cselect_b32 s37, s46, s48
  s_cselect_b32 s46, 128, 0
  s_add_u32 s21, s21, s46
  s_add_i32 s47, s47, s37
  s_max_i32 s24, s24, s37
  s_cmp_eq_u32 s3, 5
  s_cselect_b32 s53, s37, s53
  s_sub_i32 s46, s45, s22
  s_sub_i32 s48, s46, 12
  s_max_i32 s48, s38, s48
  s_sub_u32 s14, s14, s55
  s_sub_i32 s46, s46, s14
  s_cmp_lt_u32 s14, 256
  s_cselect_b32 s38, s46, s48
  s_cselect_b32 s46, 128, 0
  s_add_u32 s22, s22, s46
  s_add_i32 s47, s47, s38
  s_max_i32 s24, s24, s38
  s_cmp_eq_u32 s3, 6
  s_cselect_b32 s53, s38, s53
  s_sub_i32 s46, s45, s23
  s_sub_i32 s48, s46, 12
  s_max_i32 s48, s39, s48
  s_sub_u32 s15, s15, s55
  s_sub_i32 s46, s46, s15
  s_cmp_lt_u32 s15, 256
  s_cselect_b32 s39, s46, s48
  s_cselect_b32 s46, 128, 0
  s_add_u32 s23, s23, s46
  s_add_i32 s47, s47, s39
  s_max_i32 s24, s24, s39
  s_cmp_eq_u32 s3, 7
  s_cselect_b32 s53, s39, s53
  s_mul_i32 s47, s47, 3
  s_mul_i32 s24, s24, 8
  s_add_i32 s47, s47, s24
  s_ashr_i32 s47, s47, 2
  s_lshl_b32 s46, s53, 3
  s_sub_i32 s47, s47, s46
  s_sub_i32 s47, s47, 24
  s_mul_i32 s47, s47, 2
  s_ashr_i32 s47, s47, 5
  s_max_i32 s47, s47, -500
  s_min_i32 s47, s47, 500
  s_add_u32 s47, s47, 1024
  s_add_u32 s47, s47, s55
  v_mov_b32 v18, s47
  s_mov_b64 exec, 1
  buffer_store_dword v18, v5, s[64:67], s62 offen
  s_mov_b64 exec, -1
L_f2:
  s_sub_u32 s51, s51, 1
  s_cbranch_scc0 L_fcl
L_fcx:
  s_waitcnt lgkmcnt(0)
  s_endpgm
L_helper:
  v_lshrrev_b32 v32, 4, v2
  v_and_b32 v33, 15, v2
  v_and_b32 v34, 3, v2
  v_lshlrev_b32 v50, 2, v2
  s_mov_b32 s58, 0x05040100
  s_mov_b32 s59, 0x07060302
  s_movk_i32 s77, 0xff
  v_lshrrev_b32 v49, 3, v2
  v_add_u32 v49, v49, v2
  v_lshlrev_b32 v49, 4, v49
  s_mul_i32 s43, s3, 30
  s_add_u32 s44, s43, s78
  s_lshl_b32 s45, s44, 10
  s_add_u32 s45, s45, 2271232
  s_lshl_b32 s44, s44, 11
  s_add_u32 s44, s44, 1779712
  s_and_b32 s40, s78, 3
  s_mul_i32 s40, s40, 192
  v_lshl_add_u32 v48, v2, 2, s40
  v_lshrrev_b32 v41, 7, v48
  v_and_b32 v48, 127, v48
  v_mul_u32_u24 v41, 10240, v41
  v_lshl_add_u32 v48, v48, 2, v41
  s_lshl_b32 s46, s43, 11
  s_add_u32 s46, s46, 1779712
  v_lshlrev_b32 v51, 3, v2
  s_waitcnt lgkmcnt(0)
  s_load_dword s55, s[28:29], 0
  s_barrier
  s_cmp_ge_u32 s78, 30
  s_cbranch_scc1 L_nof
  s_mov_b32 s68, s4
  s_mov_b32 s69, s5
  s_mov_b32 s70, 5120
  s_mov_b32 s71, 0x20000
  s_cmp_ge_u32 s56, 3
  s_cselect_b32 s60, s18, s16
  s_cselect_b32 s61, s19, s17
  s_cselect_b32 s40, 3, 0
  s_mov_b32 s62, 1966080
  s_mov_b32 s63, 0x20000
  s_sub_u32 s40, s56, s40
  s_mul_i32 s41, s3, 3
  s_add_u32 s40, s40, s41
  s_lshl_b32 s40, s40, 7
  s_mul_i32 s41, s57, 393216
  s_add_u32 s40, s40, s41
  s_lshl_b32 s41, s57, 8
  v_and_b32 v41, 8, v2
  v_lshlrev_b32 v41, 2, v41
  v_lshl_add_u32 v41, v32, 3, v41
  v_mul_u32_u24 v41, 3072, v41
  v_and_b32 v43, 7, v2
  v_lshl_add_u32 v41, v43, 4, v41
  v_mul_u32_u24 v42, 1280, v34
  v_lshl_add_u32 v42, v32, 4, v42
  v_and_b32 v35, 4, v2
  v_lshl_add_u32 v42, v35, 4, v42
  buffer_load_dwordx4 v[64:67], v41, s[60:63], s40 offen nt
  s_add_u32 s40, s40, 3072
  buffer_load_dwordx4 v[68:71], v41, s[60:63], s40 offen nt
  s_add_u32 s40, s40, 3072
  buffer_load_dwordx4 v[72:75], v41, s[60:63], s40 offen nt
  s_add_u32 s40, s40, 3072
  buffer_load_dwordx4 v[76:79], v41, s[60:63], s40 offen nt
  s_add_u32 s40, s40, 3072
  buffer_load_dwordx4 v[80:83], v41, s[60:63], s40 offen nt
  s_add_u32 s40, s40, 3072
  buffer_load_dwordx4 v[84:87], v41, s[60:63], s40 offen nt
  s_add_u32 s40, s40, 3072
  buffer_load_dwordx4 v[88:91], v41, s[60:63], s40 offen nt
  s_add_u32 s40, s40, 3072
  buffer_load_dwordx4 v[92:95], v41, s[60:63], s40 offen nt
  s_add_u32 s40, s40, 175104
  buffer_load_dwordx4 v[96:99], v41, s[60:63], s40 offen nt
  s_add_u32 s40, s40, 3072
  buffer_load_dwordx4 v[100:103], v41, s[60:63], s40 offen nt
  s_add_u32 s40, s40, 3072
  buffer_load_dwordx4 v[104:107], v41, s[60:63], s40 offen nt
  s_add_u32 s40, s40, 3072
  buffer_load_dwordx4 v[108:111], v41, s[60:63], s40 offen nt
  s_add_u32 s40, s40, 3072
  buffer_load_dwordx4 v[112:115], v41, s[60:63], s40 offen nt
  s_add_u32 s40, s40, 3072
  buffer_load_dwordx4 v[116:119], v41, s[60:63], s40 offen nt
  s_add_u32 s40, s40, 3072
  buffer_load_dwordx4 v[120:123], v41, s[60:63], s40 offen nt
  s_add_u32 s40, s40, 3072
  buffer_load_dwordx4 v[124:127], v41, s[60:63], s40 offen nt
  s_add_u32 s40, s40, 175104
  s_mov_b32 s60, s20
  s_mov_b32 s61, s21
  s_mov_b32 s62, 1966080
  s_mov_b32 s63, 0x20000
  v_mul_u32_u24 v3, 10240, v32
  v_lshl_add_u32 v3, v33, 4, v3
  s_mul_i32 s40, s3, 6
  s_add_u32 s40, s40, s56
  s_mul_i32 s40, s40, 40960
  s_add_u32 s40, s40, s41
  buffer_load_dwordx4 v[128:131], v3, s[60:63], s40 offen nt
  s_add_u32 s40, s40, 1280
  buffer_load_dwordx4 v[132:135], v3, s[60:63], s40 offen nt
  s_add_u32 s40, s40, 1280
  buffer_load_dwordx4 v[136:139], v3, s[60:63], s40 offen nt
  s_add_u32 s40, s40, 1280
  buffer_load_dwordx4 v[140:143], v3, s[60:63], s40 offen nt
  s_add_u32 s40, s40, 1280
  buffer_load_dwordx4 v[144:147], v3, s[60:63], s40 offen nt
  s_add_u32 s40, s40, 1280
  buffer_load_dwordx4 v[148:151], v3, s[60:63], s40 offen nt
  s_add_u32 s40, s40, 1280
  buffer_load_dwordx4 v[152:155], v3, s[60:63], s40 offen nt
  s_add_u32 s40, s40, 1280
  buffer_load_dwordx4 v[156:159], v3, s[60:63], s40 offen nt
  s_add_u32 s40, s40, 1280
  buffer_load_dwordx4 v[8:11], v42, s[68:71], s41 offen offset:0
  buffer_load_dwordx4 v[12:15], v42, s[68:71], s41 offen offset:128
L_nof:
  s_mov_b32 s64, s28
  s_mov_b32 s65, s29
  s_mov_b32 s66, 3821568
  s_mov_b32 s67, 0x20000
  s_getreg_b32 s53, hwreg(HW_REG_XCC_ID, 0, 4)
  s_lshl_b32 s52, s3, 8
  s_add_u32 s52, s52, 1024
  s_waitcnt lgkmcnt(0)
  s_add_u32 s55, s55, 2654435769
  v_mov_b32 v26, s55
  v_and_b32 v27, 0xff, v26
  s_add_u32 s53, s53, s55
  v_lshlrev_b32 v25, 3, v34
  v_lshrrev_b32 v25, v25, v26
  v_bfe_u32 v28, v26, 0, 8
  v_bfe_u32 v29, v26, 8, 8
  v_bfe_u32 v30, v26, 16, 8
  v_bfe_u32 v31, v26, 24, 8
  s_cmp_ge_u32 s78, 30
  s_cbranch_scc1 L_hq
  s_mov_b32 s51, 1048576
L_cw:
  ds_read_b32 v42, v5 offset:408
  s_waitcnt lgkmcnt(0)
  v_cmp_gt_u32 vcc, 4, v42
  s_cbranch_vccz L_cwok
  s_sub_u32 s51, s51, 1
  s_cbranch_scc0 L_cw
L_cwok:
  ds_read_b128 v[232:235], v49 offset:3072
  ds_read_b128 v[164:167], v49 offset:5376
  ds_read_b128 v[168:171], v49 offset:7680
  ds_read_b128 v[172:175], v49 offset:9984
  ds_read_b128 v[236:239], v49 offset:4224
  ds_read_b128 v[180:183], v49 offset:6528
  ds_read_b128 v[184:187], v49 offset:8832
  ds_read_b128 v[188:191], v49 offset:11136
  s_waitcnt lgkmcnt(6)
  v_pk_add_f32 v[232:233], v[232:233], v[164:165]
  v_pk_add_f32 v[234:235], v[234:235], v[166:167]
  s_waitcnt lgkmcnt(5)
  v_pk_add_f32 v[232:233], v[232:233], v[168:169]
  v_pk_add_f32 v[234:235], v[234:235], v[170:171]
  s_waitcnt lgkmcnt(4)
  v_pk_add_f32 v[232:233], v[232:233], v[172:173]
  v_pk_add_f32 v[234:235], v[234:235], v[174:175]
  v_bfi_b32 v232, s77, v25, v232
  v_bfi_b32 v233, s77, v25, v233
  v_bfi_b32 v234, s77, v25, v234
  v_bfi_b32 v235, s77, v25, v235
  s_waitcnt lgkmcnt(2)
  v_pk_add_f32 v[236:237], v[236:237], v[180:181]
  v_pk_add_f32 v[238:239], v[238:239], v[182:183]
  s_waitcnt lgkmcnt(1)
  v_pk_add_f32 v[236:237], v[236:237], v[184:185]
  v_pk_add_f32 v[238:239], v[238:239], v[186:187]
  s_waitcnt lgkmcnt(0)
  v_pk_add_f32 v[236:237], v[236:237], v[188:189]
  v_pk_add_f32 v[238:239], v[238:239], v[190:191]
  v_bfi_b32 v236, s77, v25, v236
  v_bfi_b32 v237, s77, v25, v237
  v_bfi_b32 v238, s77, v25, v238
  v_bfi_b32 v239, s77, v25, v239
  buffer_store_dword v232, v50, s[64:67], s44 offen offset:0
  buffer_store_dword v233, v50, s[64:67], s44 offen offset:512
  buffer_store_dword v234, v50, s[64:67], s44 offen offset:1024
  buffer_store_dword v235, v50, s[64:67], s44 offen offset:1536
  buffer_store_dword v236, v50, s[64:67], s44 offen offset:256
  buffer_store_dword v237, v50, s[64:67], s44 offen offset:768
  buffer_store_dword v238, v50, s[64:67], s44 offen offset:1280
  buffer_store_dword v239, v50, s[64:67], s44 offen offset:1792
L_hq:
  s_mov_b32 s51, 1048576
  s_mov_b32 s47, 0
L_poll0:
  s_mov_b32 exec_hi, 0xffff
  s_mov_b32 s42, s46
  s_cmp_lt_u32 s51, 1048564
  s_cbranch_scc1 L_q5s
  buffer_load_dwordx4 v[160:163], v48, s[64:67], s42 offen sc1
  s_addk_i32 s42, 2048
  buffer_load_dwordx4 v[164:167], v48, s[64:67], s42 offen sc1
  s_addk_i32 s42, 2048
  buffer_load_dwordx4 v[168:171], v48, s[64:67], s42 offen sc1
  s_addk_i32 s42, 2048
  buffer_load_dwordx4 v[172:175], v48, s[64:67], s42 offen sc1
  s_addk_i32 s42, 2048
  buffer_load_dwordx4 v[176:179], v48, s[64:67], s42 offen sc1
  s_addk_i32 s42, 2048
  s_branch L_q5d
L_q5s:
  buffer_load_dwordx4 v[160:163], v48, s[64:67], s42 offen sc1
  s_addk_i32 s42, 2048
  buffer_load_dwordx4 v[164:167], v48, s[64:67], s42 offen sc1
  s_addk_i32 s42, 2048
  buffer_load_dwordx4 v[168:171], v48, s[64:67], s42 offen sc1
  s_addk_i32 s42, 2048
  buffer_load_dwordx4 v[172:175], v48, s[64:67], s42 offen sc1
  s_addk_i32 s42, 2048
  buffer_load_dwordx4 v[176:179], v48, s[64:67], s42 offen sc1
  s_addk_i32 s42, 2048
L_q5d:
  s_waitcnt vmcnt(4)
  v_xor_b32 v160, v28, v160
  v_xor_b32 v161, v29, v161
  v_xor_b32 v162, v30, v162
  v_xor_b32 v163, v31, v163
  v_or3_b32 v53, v160, v161, v162
  v_or_b32 v53, v53, v163
  s_waitcnt vmcnt(3)
  v_xor_b32 v164, v28, v164
  v_xor_b32 v165, v29, v165
  v_xor_b32 v166, v30, v166
  v_xor_b32 v167, v31, v167
  v_or3_b32 v53, v53, v164, v165
  v_pk_add_f32 v[160:161], v[160:161], v[164:165]
  v_or3_b32 v53, v53, v166, v167
  v_pk_add_f32 v[162:163], v[162:163], v[166:167]
  s_waitcnt vmcnt(2)
  v_xor_b32 v168, v28, v168
  v_xor_b32 v169, v29, v169
  v_xor_b32 v170, v30, v170
  v_xor_b32 v171, v31, v171
  v_or3_b32 v53, v53, v168, v169
  v_pk_add_f32 v[160:161], v[160:161], v[168:169]
  v_or3_b32 v53, v53, v170, v171
  v_pk_add_f32 v[162:163], v[162:163], v[170:171]
  s_waitcnt vmcnt(1)
  v_xor_b32 v172, v28, v172
  v_xor_b32 v173, v29, v173
  v_xor_b32 v174, v30, v174
  v_xor_b32 v175, v31, v175
  v_or3_b32 v53, v53, v172, v173
  v_pk_add_f32 v[160:161], v[160:161], v[172:173]
  v_or3_b32 v53, v53, v174, v175
  v_pk_add_f32 v[162:163], v[162:163], v[174:175]
  s_waitcnt vmcnt(0)
  v_xor_b32 v176, v28, v176
  v_xor_b32 v177, v29, v177
  v_xor_b32 v178, v30, v178
  v_xor_b32 v179, v31, v179
  v_or3_b32 v53, v53, v176, v177
  v_pk_add_f32 v[160:161], v[160:161], v[176:177]
  v_or3_b32 v53, v53, v178, v179
  v_pk_add_f32 v[162:163], v[162:163], v[178:179]
  v_and_b32 v53, s77, v53
  v_cmp_ne_u32 vcc, 0, v53
  s_cbranch_vccz L_got0
  s_cmp_lg_u32 s51, 1048564
  s_cbranch_scc1 L_nofall
  s_cmp_ge_u32 s78, 30
  s_cbranch_scc1 L_nofall
  s_mov_b64 exec, -1
  buffer_store_dword v232, v50, s[64:67], s44 offen offset:0 sc1
  buffer_store_dword v233, v50, s[64:67], s44 offen offset:512 sc1
  buffer_store_dword v234, v50, s[64:67], s44 offen offset:1024 sc1
  buffer_store_dword v235, v50, s[64:67], s44 offen offset:1536 sc1
  buffer_store_dword v236, v50, s[64:67], s44 offen offset:256 sc1
  buffer_store_dword v237, v50, s[64:67], s44 offen offset:768 sc1
  buffer_store_dword v238, v50, s[64:67], s44 offen offset:1280 sc1
  buffer_store_dword v239, v50, s[64:67], s44 offen offset:1792 sc1
L_nofall:
  s_sleep 8
  s_sub_u32 s51, s51, 1
  s_cbranch_scc0 L_poll0
  s_mov_b32 s51, 0
L_got0:
  s_mov_b32 exec_hi, 0xffff
  v_cvt_pk_bf16_f32 v160, v160, v161
  v_cvt_pk_bf16_f32 v161, v162, v163
  ds_write_b64 v51, v[160:161] offset:1536
  s_add_u32 s47, s47, 1
  s_lshr_b32 s40, s47, 2
  s_add_u32 s40, s40, 1
  v_mov_b32 v41, s40
  ds_write_b32 v5, v41 offset:404
  v_add_u32 v51, 384, v51
  s_addk_i32 s46, 512
  s_cmp_lg_u32 s47, 1
  s_cbranch_scc1 L_q3n
  s_cmp_lt_u32 s51, 1048564
  s_cbranch_scc1 L_poll0
  s_mov_b32 s42, s46
  buffer_load_dwordx4 v[160:163], v48, s[64:67], s42 offen offset:0 sc1
  s_addk_i32 s42, 2048
  buffer_load_dwordx4 v[164:167], v48, s[64:67], s42 offen offset:0 sc1
  s_addk_i32 s42, 2048
  buffer_load_dwordx4 v[168:171], v48, s[64:67], s42 offen offset:0 sc1
  s_addk_i32 s42, 2048
  buffer_load_dwordx4 v[172:175], v48, s[64:67], s42 offen offset:0 sc1
  s_addk_i32 s42, 2048
  buffer_load_dwordx4 v[176:179], v48, s[64:67], s42 offen offset:0 sc1
  s_addk_i32 s42, 2048
  s_mov_b32 s42, s46
  buffer_load_dwordx4 v[180:183], v48, s[64:67], s42 offen offset:512 sc1
  s_addk_i32 s42, 2048
  buffer_load_dwordx4 v[184:187], v48, s[64:67], s42 offen offset:512 sc1
  s_addk_i32 s42, 2048
  buffer_load_dwordx4 v[188:191], v48, s[64:67], s42 offen offset:512 sc1
  s_addk_i32 s42, 2048
  buffer_load_dwordx4 v[192:195], v48, s[64:67], s42 offen offset:512 sc1
  s_addk_i32 s42, 2048
  buffer_load_dwordx4 v[196:199], v48, s[64:67], s42 offen offset:512 sc1
  s_addk_i32 s42, 2048
  s_mov_b32 s42, s46
  buffer_load_dwordx4 v[200:203], v48, s[64:67], s42 offen offset:1024 sc1
  s_addk_i32 s42, 2048
  buffer_load_dwordx4 v[204:207], v48, s[64:67], s42 offen offset:1024 sc1
  s_addk_i32 s42, 2048
  buffer_load_dwordx4 v[208:211], v48, s[64:67], s42 offen offset:1024 sc1
  s_addk_i32 s42, 2048
  buffer_load_dwordx4 v[212:215], v48, s[64:67], s42 offen offset:1024 sc1
  s_addk_i32 s42, 2048
  buffer_load_dwordx4 v[216:219], v48, s[64:67], s42 offen offset:1024 sc1
  s_addk_i32 s42, 2048
  s_waitcnt vmcnt(14)
  v_xor_b32 v160, v28, v160
  v_xor_b32 v161, v29, v161
  v_xor_b32 v162, v30, v162
  v_xor_b32 v163, v31, v163
  v_or3_b32 v53, v160, v161, v162
  v_or_b32 v53, v53, v163
  s_waitcnt vmcnt(13)
  v_xor_b32 v164, v28, v164
  v_xor_b32 v165, v29, v165
  v_xor_b32 v166, v30, v166
  v_xor_b32 v167, v31, v167
  v_or3_b32 v53, v53, v164, v165
  v_pk_add_f32 v[160:161], v[160:161], v[164:165]
  v_or3_b32 v53, v53, v166, v167
  v_pk_add_f32 v[162:163], v[162:163], v[166:167]
  s_waitcnt vmcnt(12)
  v_xor_b32 v168, v28, v168
  v_xor_b32 v169, v29, v169
  v_xor_b32 v170, v30, v170
  v_xor_b32 v171, v31, v171
  v_or3_b32 v53, v53, v168, v169
  v_pk_add_f32 v[160:161], v[160:161], v[168:169]
  v_or3_b32 v53, v53, v170, v171
  v_pk_add_f32 v[162:163], v[162:163], v[170:171]
  s_waitcnt vmcnt(11)
  v_xor_b32 v172, v28, v172
  v_xor_b32 v173, v29, v173
  v_xor_b32 v174, v30, v174
  v_xor_b32 v175, v31, v175
  v_or3_b32 v53, v53, v172, v173
  v_pk_add_f32 v[160:161], v[160:161], v[172:173]
  v_or3_b32 v53, v53, v174, v175
  v_pk_add_f32 v[162:163], v[162:163], v[174:175]
  s_waitcnt vmcnt(10)
  v_xor_b32 v176, v28, v176
  v_xor_b32 v177, v29, v177
  v_xor_b32 v178, v30, v178
  v_xor_b32 v179, v31, v179
  v_or3_b32 v53, v53, v176, v177
  v_pk_add_f32 v[160:161], v[160:161], v[176:177]
  v_or3_b32 v53, v53, v178, v179
  v_pk_add_f32 v[162:163], v[162:163], v[178:179]
  v_and_b32 v53, s77, v53
  v_cmp_ne_u32 vcc, 0, v53
  s_cbranch_vccnz L_poll0
  s_waitcnt vmcnt(9)
  v_xor_b32 v180, v28, v180
  v_xor_b32 v181, v29, v181
  v_xor_b32 v182, v30, v182
  v_xor_b32 v183, v31, v183
  v_or3_b32 v53, v180, v181, v182
  v_or_b32 v53, v53, v183
  s_waitcnt vmcnt(8)
  v_xor_b32 v184, v28, v184
  v_xor_b32 v185, v29, v185
  v_xor_b32 v186, v30, v186
  v_xor_b32 v187, v31, v187
  v_or3_b32 v53, v53, v184, v185
  v_pk_add_f32 v[180:181], v[180:181], v[184:185]
  v_or3_b32 v53, v53, v186, v187
  v_pk_add_f32 v[182:183], v[182:183], v[186:187]
  s_waitcnt vmcnt(7)
  v_xor_b32 v188, v28, v188
  v_xor_b32 v189, v29, v189
  v_xor_b32 v190, v30, v190
  v_xor_b32 v191, v31, v191
  v_or3_b32 v53, v53, v188, v189
  v_pk_add_f32 v[180:181], v[180:181], v[188:189]
  v_or3_b32 v53, v53, v190, v191
  v_pk_add_f32 v[182:183], v[182:183], v[190:191]
  s_waitcnt vmcnt(6)
  v_xor_b32 v192, v28, v192
  v_xor_b32 v193, v29, v193
  v_xor_b32 v194, v30, v194
  v_xor_b32 v195, v31, v195
  v_or3_b32 v53, v53, v192, v193
  v_pk_add_f32 v[180:181], v[180:181], v[192:193]
  v_or3_b32 v53, v53, v194, v195
  v_pk_add_f32 v[182:183], v[182:183], v[194:195]
  s_waitcnt vmcnt(5)
  v_xor_b32 v196, v28, v196
  v_xor_b32 v197, v29, v197
  v_xor_b32 v198, v30, v198
  v_xor_b32 v199, v31, v199
  v_or3_b32 v53, v53, v196, v197
  v_pk_add_f32 v[180:181], v[180:181], v[196:197]
  v_or3_b32 v53, v53, v198, v199
  v_pk_add_f32 v[182:183], v[182:183], v[198:199]
  v_and_b32 v53, s77, v53
  v_cmp_ne_u32 vcc, 0, v53
  s_cbranch_vccnz L_poll0
  s_waitcnt vmcnt(4)
  v_xor_b32 v200, v28, v200
  v_xor_b32 v201, v29, v201
  v_xor_b32 v202, v30, v202
  v_xor_b32 v203, v31, v203
  v_or3_b32 v53, v200, v201, v202
  v_or_b32 v53, v53, v203
  s_waitcnt vmcnt(3)
  v_xor_b32 v204, v28, v204
  v_xor_b32 v205, v29, v205
  v_xor_b32 v206, v30, v206
  v_xor_b32 v207, v31, v207
  v_or3_b32 v53, v53, v204, v205
  v_pk_add_f32 v[200:201], v[200:201], v[204:205]
  v_or3_b32 v53, v53, v206, v207
  v_pk_add_f32 v[202:203], v[202:203], v[206:207]
  s_waitcnt vmcnt(2)
  v_xor_b32 v208, v28, v208
  v_xor_b32 v209, v29, v209
  v_xor_b32 v210, v30, v210
  v_xor_b32 v211, v31, v211
  v_or3_b32 v53, v53, v208, v209
  v_pk_add_f32 v[200:201], v[200:201], v[208:209]
  v_or3_b32 v53, v53, v210, v211
  v_pk_add_f32 v[202:203], v[202:203], v[210:211]
  s_waitcnt vmcnt(1)
  v_xor_b32 v212, v28, v212
  v_xor_b32 v213, v29, v213
  v_xor_b32 v214, v30, v214
  v_xor_b32 v215, v31, v215
  v_or3_b32 v53, v53, v212, v213
  v_pk_add_f32 v[200:201], v[200:201], v[212:213]
  v_or3_b32 v53, v53, v214, v215
  v_pk_add_f32 v[202:203], v[202:203], v[214:215]
  s_waitcnt vmcnt(0)
  v_xor_b32 v216, v28, v216
  v_xor_b32 v217, v29, v217
  v_xor_b32 v218, v30, v218
  v_xor_b32 v219, v31, v219
  v_or3_b32 v53, v53, v216, v217
  v_pk_add_f32 v[200:201], v[200:201], v[216:217]
  v_or3_b32 v53, v53, v218, v219
  v_pk_add_f32 v[202:203], v[202:203], v[218:219]
  v_and_b32 v53, s77, v53
  v_cmp_ne_u32 vcc, 0, v53
  s_cbranch_vccnz L_poll0
  v_cvt_pk_bf16_f32 v160, v160, v161
  v_cvt_pk_bf16_f32 v161, v162, v163
  ds_write_b64 v51, v[160:161] offset:1536
  v_cvt_pk_bf16_f32 v180, v180, v181
  v_cvt_pk_bf16_f32 v181, v182, v183
  ds_write_b64 v51, v[180:181] offset:1920
  v_cvt_pk_bf16_f32 v200, v200, v201
  v_cvt_pk_bf16_f32 v201, v202, v203
  ds_write_b64 v51, v[200:201] offset:2304
  v_mov_b32 v41, 2
  ds_write_b32 v5, v41 offset:404
  s_mov_b32 s47, 4
L_q3n:
  s_cmp_lt_u32 s47, 4
  s_cbranch_scc1 L_poll0
  s_mov_b64 exec, -1
  s_lshl_b32 s40, s78, 2
  v_mov_b32 v41, s53
  v_mov_b32 v42, s40
  s_mov_b64 exec, 1
  buffer_store_dword v41, v42, s[64:67], s52 offen
  s_mov_b64 exec, -1
  s_cmp_ge_u32 s78, 30
  s_cbranch_scc1 L_hg
  v_and_b32 v43, 7, v2
  v_mul_u32_u24 v41, 1152, v32
  v_mul_u32_u24 v43, 144, v43
  v_add_u32 v41, v41, v43
  s_waitcnt vmcnt(0)
  v_perm_b32 v224, v68, v64, s58
  v_perm_b32 v225, v76, v72, s58
  v_perm_b32 v226, v84, v80, s58
  v_perm_b32 v227, v92, v88, s58
  v_perm_b32 v228, v68, v64, s59
  v_perm_b32 v229, v76, v72, s59
  v_perm_b32 v230, v84, v80, s59
  v_perm_b32 v231, v92, v88, s59
  v_mfma_f32_16x16x32_bf16 v[192:195], v[8:11], v[224:227], 0
  v_perm_b32 v224, v69, v65, s58
  v_perm_b32 v225, v77, v73, s58
  v_perm_b32 v226, v85, v81, s58
  v_perm_b32 v227, v93, v89, s58
  v_mfma_f32_16x16x32_bf16 v[196:199], v[8:11], v[228:231], 0
  v_perm_b32 v228, v69, v65, s59
  v_perm_b32 v229, v77, v73, s59
  v_perm_b32 v230, v85, v81, s59
  v_perm_b32 v231, v93, v89, s59
  v_mfma_f32_16x16x32_bf16 v[200:203], v[8:11], v[224:227], 0
  v_perm_b32 v224, v70, v66, s58
  v_perm_b32 v225, v78, v74, s58
  v_perm_b32 v226, v86, v82, s58
  v_perm_b32 v227, v94, v90, s58
  v_mfma_f32_16x16x32_bf16 v[204:207], v[8:11], v[228:231], 0
  v_perm_b32 v228, v70, v66, s59
  v_perm_b32 v229, v78, v74, s59
  v_perm_b32 v230, v86, v82, s59
  v_perm_b32 v231, v94, v90, s59
  v_mfma_f32_16x16x32_bf16 v[208:211], v[8:11], v[224:227], 0
  v_perm_b32 v224, v71, v67, s58
  v_perm_b32 v225, v79, v75, s58
  v_perm_b32 v226, v87, v83, s58
  v_perm_b32 v227, v95, v91, s58
  v_mfma_f32_16x16x32_bf16 v[212:215], v[8:11], v[228:231], 0
  v_perm_b32 v228, v71, v67, s59
  v_perm_b32 v229, v79, v75, s59
  v_perm_b32 v230, v87, v83, s59
  v_perm_b32 v231, v95, v91, s59
  v_mfma_f32_16x16x32_bf16 v[216:219], v[8:11], v[224:227], 0
  s_nop 1
  v_mfma_f32_16x16x32_bf16 v[220:223], v[8:11], v[228:231], 0
  v_perm_b32 v224, v100, v96, s58
  v_perm_b32 v225, v108, v104, s58
  v_perm_b32 v226, v116, v112, s58
  v_perm_b32 v227, v124, v120, s58
  v_perm_b32 v228, v100, v96, s59
  v_perm_b32 v229, v108, v104, s59
  v_perm_b32 v230, v116, v112, s59
  v_perm_b32 v231, v124, v120, s59
  v_mfma_f32_16x16x32_bf16 v[192:195], v[12:15], v[224:227], v[192:195]
  v_perm_b32 v224, v101, v97, s58
  v_perm_b32 v225, v109, v105, s58
  v_perm_b32 v226, v117, v113, s58
  v_perm_b32 v227, v125, v121, s58
  v_mfma_f32_16x16x32_bf16 v[196:199], v[12:15], v[228:231], v[196:199]
  v_perm_b32 v228, v101, v97, s59
  v_perm_b32 v229, v109, v105, s59
  v_perm_b32 v230, v117, v113, s59
  v_perm_b32 v231, v125, v121, s59
  v_mfma_f32_16x16x32_bf16 v[200:203], v[12:15], v[224:227], v[200:203]
  v_perm_b32 v224, v102, v98, s58
  v_perm_b32 v225, v110, v106, s58
  v_perm_b32 v226, v118, v114, s58
  v_perm_b32 v227, v126, v122, s58
  v_mfma_f32_16x16x32_bf16 v[204:207], v[12:15], v[228:231], v[204:207]
  v_perm_b32 v228, v102, v98, s59
  v_perm_b32 v229, v110, v106, s59
  v_perm_b32 v230, v118, v114, s59
  v_perm_b32 v231, v126, v122, s59
  v_mfma_f32_16x16x32_bf16 v[208:211], v[12:15], v[224:227], v[208:211]
  v_perm_b32 v224, v103, v99, s58
  v_perm_b32 v225, v111, v107, s58
  v_perm_b32 v226, v119, v115, s58
  v_perm_b32 v227, v127, v123, s58
  v_mfma_f32_16x16x32_bf16 v[212:215], v[12:15], v[228:231], v[212:215]
  v_perm_b32 v228, v103, v99, s59
  v_perm_b32 v229, v111, v107, s59
  v_perm_b32 v230, v119, v115, s59
  v_perm_b32 v231, v127, v123, s59
  v_mfma_f32_16x16x32_bf16 v[216:219], v[12:15], v[224:227], v[216:219]
  s_nop 1
  v_mfma_f32_16x16x32_bf16 v[220:223], v[12:15], v[228:231], v[220:223]
  s_mov_b32 exec_lo, 0xff0000ff
  s_mov_b32 exec_hi, 0
  ds_write_b128 v41, v[192:195] offset:3072
  ds_write_b128 v41, v[196:199] offset:3088
  ds_write_b128 v41, v[200:203] offset:3104
  ds_write_b128 v41, v[204:207] offset:3120
  ds_write_b128 v41, v[208:211] offset:3136
  ds_write_b128 v41, v[212:215] offset:3152
  ds_write_b128 v41, v[216:219] offset:3168
  ds_write_b128 v41, v[220:223] offset:3184
  s_mov_b64 exec, -1
  ds_read_b128 v[240:243], v49 offset:3072
  ds_read_b128 v[244:247], v49 offset:4224
  s_waitcnt lgkmcnt(0)
  v_pk_add_f32 v[240:241], v[240:241], v[244:245]
  v_pk_add_f32 v[242:243], v[242:243], v[246:247]
  v_bfi_b32 v240, s77, v25, v240
  v_bfi_b32 v241, s77, v25, v241
  v_bfi_b32 v242, s77, v25, v242
  v_bfi_b32 v243, s77, v25, v243
L_hg:
  s_mov_b32 s68, s4
  s_mov_b32 s69, s5
  s_mov_b32 s70, 5120
  s_mov_b32 s71, 0x20000
  s_mov_b32 s36, s22
  s_mov_b32 s37, s23
  s_mov_b32 s38, 1280
  s_mov_b32 s39, 0x20000
  v_mul_u32_u24 v42, 1280, v32
  v_lshl_add_u32 v42, v33, 4, v42
  v_lshlrev_b32 v41, 4, v33
  buffer_load_dwordx4 v[64:67], v42, s[68:71], 0 offen offset:0
  buffer_load_dwordx4 v[84:87], v41, s[36:39], 0 offen offset:0
  buffer_load_dwordx4 v[68:71], v42, s[68:71], 0 offen offset:256
  buffer_load_dwordx4 v[88:91], v41, s[36:39], 0 offen offset:256
  buffer_load_dwordx4 v[72:75], v42, s[68:71], 0 offen offset:512
  buffer_load_dwordx4 v[92:95], v41, s[36:39], 0 offen offset:512
  buffer_load_dwordx4 v[76:79], v42, s[68:71], 0 offen offset:768
  buffer_load_dwordx4 v[96:99], v41, s[36:39], 0 offen offset:768
  buffer_load_dwordx4 v[80:83], v42, s[68:71], 0 offen offset:1024
  buffer_load_dwordx4 v[100:103], v41, s[36:39], 0 offen offset:1024
  s_waitcnt vmcnt(0)
  v_dot2_f32_bf16 v52, v64, v84, 0
  v_dot2_f32_bf16 v52, v65, v85, v52
  v_dot2_f32_bf16 v52, v66, v86, v52
  v_dot2_f32_bf16 v52, v67, v87, v52
  v_dot2_f32_bf16 v52, v68, v88, v52
  v_dot2_f32_bf16 v52, v69, v89, v52
  v_dot2_f32_bf16 v52, v70, v90, v52
  v_dot2_f32_bf16 v52, v71, v91, v52
  v_dot2_f32_bf16 v52, v72, v92, v52
  v_dot2_f32_bf16 v52, v73, v93, v52
  v_dot2_f32_bf16 v52, v74, v94, v52
  v_dot2_f32_bf16 v52, v75, v95, v52
  v_dot2_f32_bf16 v52, v76, v96, v52
  v_dot2_f32_bf16 v52, v77, v97, v52
  v_dot2_f32_bf16 v52, v78, v98, v52
  v_dot2_f32_bf16 v52, v79, v99, v52
  v_dot2_f32_bf16 v52, v80, v100, v52
  v_dot2_f32_bf16 v52, v81, v101, v52
  v_dot2_f32_bf16 v52, v82, v102, v52
  v_dot2_f32_bf16 v52, v83, v103, v52
  s_nop 2
  v_add_f32_dpp v52, v52, v52 quad_perm:[1,0,3,2] row_mask:0xf bank_mask:0xf
  s_nop 1
  v_add_f32_dpp v52, v52, v52 quad_perm:[2,3,0,1] row_mask:0xf bank_mask:0xf
  s_nop 1
  v_add_f32_dpp v52, v52, v52 row_half_mirror row_mask:0xf bank_mask:0xf
  s_nop 1
  v_add_f32_dpp v52, v52, v52 row_mirror row_mask:0xf bank_mask:0xf
  s_nop 1
  v_mul_f32 v52, 0xbfb8aa3b, v52
  v_exp_f32 v52, v52
  s_nop 0
  v_add_f32 v52, 1.0, v52
  v_rcp_f32 v52, v52
  v_lshlrev_b32 v41, 2, v32
  v_mov_b32 v42, 1
  ds_write_b32 v41, v52 offset:384
  ds_write_b32 v5, v42 offset:420
  ds_read_b128 v[44:47], v5 offset:384
L_hwait:
  s_mov_b32 s51, 1048576
L_sig:
  ds_read_b32 v41, v5 offset:512
  s_waitcnt lgkmcnt(0)
  v_cmp_gt_u32 vcc, 300, v41
  s_cbranch_vccz L_sigok
  s_sleep 8
  s_sub_u32 s51, s51, 1
  s_cbranch_scc0 L_sig
L_sigok:
  s_cmp_lt_u32 s2, 176
  s_cbranch_scc1 L_notouch
  s_sub_u32 s40, s2, 176
  s_mul_i32 s40, s40, 6272
  s_add_u32 s40, s40, 3319808
  v_min_u32 v41, 47, v2
  v_lshlrev_b32 v41, 7, v41
  buffer_load_dword v42, v41, s[64:67], s40 offen sc1
  s_waitcnt vmcnt(0)
L_notouch:
  v_and_b32 v41, 124, v50
  buffer_load_dword v42, v41, s[64:67], s52 offen nt
  s_waitcnt vmcnt(0)
  v_cmp_ne_u32 vcc, s53, v42
  s_cbranch_vccnz L_noloc
  v_mov_b32 v41, 1
  ds_write_b32 v5, v41 offset:412
  s_cmp_ge_u32 s78, 30
  s_cbranch_scc1 L_soft
  buffer_store_dword v240, v50, s[64:67], s45 offen offset:0
  buffer_store_dword v241, v50, s[64:67], s45 offen offset:256
  buffer_store_dword v242, v50, s[64:67], s45 offen offset:512
  buffer_store_dword v243, v50, s[64:67], s45 offen offset:768
  s_branch L_fdone
L_noloc:
  v_mov_b32 v41, 2
  ds_write_b32 v5, v41 offset:412
  s_cmp_ge_u32 s78, 30
  s_cbranch_scc1 L_soft
  buffer_store_dword v232, v50, s[64:67], s44 offen offset:0 sc1
  buffer_store_dword v233, v50, s[64:67], s44 offen offset:512 sc1
  buffer_store_dword v234, v50, s[64:67], s44 offen offset:1024 sc1
  buffer_store_dword v235, v50, s[64:67], s44 offen offset:1536 sc1
  buffer_store_dword v236, v50, s[64:67], s44 offen offset:256 sc1
  buffer_store_dword v237, v50, s[64:67], s44 offen offset:768 sc1
  buffer_store_dword v238, v50, s[64:67], s44 offen offset:1280 sc1
  buffer_store_dword v239, v50, s[64:67], s44 offen offset:1792 sc1
  buffer_store_dword v240, v50, s[64:67], s45 offen offset:0 sc1
  buffer_store_dword v241, v50, s[64:67], s45 offen offset:256 sc1
  buffer_store_dword v242, v50, s[64:67], s45 offen offset:512 sc1
  buffer_store_dword v243, v50, s[64:67], s45 offen offset:768 sc1
L_fdone:
  s_mov_b32 s51, 1048576
L_sig2:
  ds_read_b32 v41, v5 offset:512
  s_waitcnt lgkmcnt(0)
  v_cmp_gt_u32 vcc, 600, v41
  s_cbranch_vccz L_sig2ok
  s_sleep 8
  s_sub_u32 s51, s51, 1
  s_cbranch_scc0 L_sig2
L_sig2ok:
  s_lshr_b32 s40, s56, 1
  s_mul_i32 s40, s40, 5
  s_add_u32 s40, s40, s43
  s_lshl_b32 s40, s40, 10
  s_and_b32 s41, s56, 1
  s_lshl_b32 s41, s41, 7
  s_add_u32 s40, s40, s41
  s_add_u32 s40, s40, 2271232
  v_bfe_u32 v42, v2, 2, 1
  v_mul_u32_u24 v42, 15360, v42
  v_lshl_add_u32 v42, v34, 8, v42
  v_lshl_add_u32 v42, v32, 5, v42
  v_and_b32 v41, 8, v2
  v_lshl_add_u32 v42, v41, 1, v42
  s_mov_b32 s51, 1048576
L_poll3:
  s_mov_b32 s42, s40
  s_cmp_lt_u32 s51, 1048564
  s_cbranch_scc1 L_f5s
  buffer_load_dwordx4 v[160:163], v42, s[64:67], s42 offen sc1
  s_addk_i32 s42, 1024
  buffer_load_dwordx4 v[164:167], v42, s[64:67], s42 offen sc1
  s_addk_i32 s42, 1024
  buffer_load_dwordx4 v[168:171], v42, s[64:67], s42 offen sc1
  s_addk_i32 s42, 1024
  buffer_load_dwordx4 v[172:175], v42, s[64:67], s42 offen sc1
  s_addk_i32 s42, 1024
  buffer_load_dwordx4 v[176:179], v42, s[64:67], s42 offen sc1
  s_addk_i32 s42, 1024
  s_branch L_f5d
L_f5s:
  buffer_load_dwordx4 v[160:163], v42, s[64:67], s42 offen sc1
  s_addk_i32 s42, 1024
  buffer_load_dwordx4 v[164:167], v42, s[64:67], s42 offen sc1
  s_addk_i32 s42, 1024
  buffer_load_dwordx4 v[168:171], v42, s[64:67], s42 offen sc1
  s_addk_i32 s42, 1024
  buffer_load_dwordx4 v[172:175], v42, s[64:67], s42 offen sc1
  s_addk_i32 s42, 1024
  buffer_load_dwordx4 v[176:179], v42, s[64:67], s42 offen sc1
  s_addk_i32 s42, 1024
L_f5d:
  s_waitcnt vmcnt(4)
  v_xor_b32 v160, v28, v160
  v_xor_b32 v161, v29, v161
  v_xor_b32 v162, v30, v162
  v_xor_b32 v163, v31, v163
  v_or3_b32 v53, v160, v161, v162
  v_or_b32 v53, v53, v163
  s_waitcnt vmcnt(3)
  v_xor_b32 v164, v28, v164
  v_xor_b32 v165, v29, v165
  v_xor_b32 v166, v30, v166
  v_xor_b32 v167, v31, v167
  v_or3_b32 v53, v53, v164, v165
  v_pk_add_f32 v[160:161], v[160:161], v[164:165]
  v_or3_b32 v53, v53, v166, v167
  v_pk_add_f32 v[162:163], v[162:163], v[166:167]
  s_waitcnt vmcnt(2)
  v_xor_b32 v168, v28, v168
  v_xor_b32 v169, v29, v169
  v_xor_b32 v170, v30, v170
  v_xor_b32 v171, v31, v171
  v_or3_b32 v53, v53, v168, v169
  v_pk_add_f32 v[160:161], v[160:161], v[168:169]
  v_or3_b32 v53, v53, v170, v171
  v_pk_add_f32 v[162:163], v[162:163], v[170:171]
  s_waitcnt vmcnt(1)
  v_xor_b32 v172, v28, v172
  v_xor_b32 v173, v29, v173
  v_xor_b32 v174, v30, v174
  v_xor_b32 v175, v31, v175
  v_or3_b32 v53, v53, v172, v173
  v_pk_add_f32 v[160:161], v[160:161], v[172:173]
  v_or3_b32 v53, v53, v174, v175
  v_pk_add_f32 v[162:163], v[162:163], v[174:175]
  s_waitcnt vmcnt(0)
  v_xor_b32 v176, v28, v176
  v_xor_b32 v177, v29, v177
  v_xor_b32 v178, v30, v178
  v_xor_b32 v179, v31, v179
  v_or3_b32 v53, v53, v176, v177
  v_pk_add_f32 v[160:161], v[160:161], v[176:177]
  v_or3_b32 v53, v53, v178, v179
  v_pk_add_f32 v[162:163], v[162:163], v[178:179]
  v_and_b32 v53, s77, v53
  v_cmp_ne_u32 vcc, 0, v53
  s_cbranch_vccz L_got3
  s_sleep 16
  s_sub_u32 s51, s51, 1
  s_cbranch_scc0 L_poll3
L_got3:
  v_mov_b32_dpp v164, v160 row_shl:4 row_mask:0xf bank_mask:0xf bound_ctrl:0
  v_mov_b32_dpp v165, v161 row_shl:4 row_mask:0xf bank_mask:0xf bound_ctrl:0
  v_mov_b32_dpp v166, v162 row_shl:4 row_mask:0xf bank_mask:0xf bound_ctrl:0
  v_mov_b32_dpp v167, v163 row_shl:4 row_mask:0xf bank_mask:0xf bound_ctrl:0
  s_mov_b32 s41, 0xbdd2d3e8
  v_mov_b32 v41, 0xc0135761
  v_mul_f32 v168, v160, v160
  v_mul_f32 v169, v161, v161
  v_mul_f32 v170, v162, v162
  v_mul_f32 v171, v163, v163
  v_fma_f32 v168, v168, s41, v41
  v_fma_f32 v169, v169, s41, v41
  v_fma_f32 v170, v170, s41, v41
  v_fma_f32 v171, v171, s41, v41
  v_mul_f32 v168, v168, v160
  v_mul_f32 v169, v169, v161
  v_mul_f32 v170, v170, v162
  v_mul_f32 v171, v171, v163
  v_exp_f32 v168, v168
  v_exp_f32 v169, v169
  v_exp_f32 v170, v170
  v_exp_f32 v171, v171
  s_nop 0
  v_add_f32 v168, 1.0, v168
  v_add_f32 v169, 1.0, v169
  v_add_f32 v170, 1.0, v170
  v_add_f32 v171, 1.0, v171
  v_rcp_f32 v168, v168
  v_rcp_f32 v169, v169
  v_rcp_f32 v170, v170
  v_rcp_f32 v171, v171
  v_mul_f32 v160, v160, v164
  v_mul_f32 v161, v161, v165
  v_mul_f32 v162, v162, v166
  v_mul_f32 v163, v163, v167
  v_mul_f32 v160, v160, v168
  v_mul_f32 v161, v161, v169
  v_mul_f32 v162, v162, v170
  v_mul_f32 v163, v163, v171
  v_cvt_pk_bf16_f32 v8, v160, v161
  v_cvt_pk_bf16_f32 v9, v162, v163
  s_nop 1
  v_mov_b32_dpp v10, v8 row_ror:8 row_mask:0xf bank_mask:0xf
  v_mov_b32_dpp v11, v9 row_ror:8 row_mask:0xf bank_mask:0xf
  v_perm_b32 v224, v132, v128, s58
  v_perm_b32 v225, v140, v136, s58
  v_perm_b32 v226, v148, v144, s58
  v_perm_b32 v227, v156, v152, s58
  v_perm_b32 v228, v132, v128, s59
  v_perm_b32 v229, v140, v136, s59
  v_perm_b32 v230, v148, v144, s59
  v_perm_b32 v231, v156, v152, s59
  v_mfma_f32_16x16x32_bf16 v[192:195], v[8:11], v[224:227], 0
  v_perm_b32 v224, v133, v129, s58
  v_perm_b32 v225, v141, v137, s58
  v_perm_b32 v226, v149, v145, s58
  v_perm_b32 v227, v157, v153, s58
  v_mfma_f32_16x16x32_bf16 v[196:199], v[8:11], v[228:231], 0
  v_perm_b32 v228, v133, v129, s59
  v_perm_b32 v229, v141, v137, s59
  v_perm_b32 v230, v149, v145, s59
  v_perm_b32 v231, v157, v153, s59
  v_mfma_f32_16x16x32_bf16 v[200:203], v[8:11], v[224:227], 0
  v_perm_b32 v224, v134, v130, s58
  v_perm_b32 v225, v142, v138, s58
  v_perm_b32 v226, v150, v146, s58
  v_perm_b32 v227, v158, v154, s58
  v_mfma_f32_16x16x32_bf16 v[204:207], v[8:11], v[228:231], 0
  v_perm_b32 v228, v134, v130, s59
  v_perm_b32 v229, v142, v138, s59
  v_perm_b32 v230, v150, v146, s59
  v_perm_b32 v231, v158, v154, s59
  v_mfma_f32_16x16x32_bf16 v[208:211], v[8:11], v[224:227], 0
  v_perm_b32 v224, v135, v131, s58
  v_perm_b32 v225, v143, v139, s58
  v_perm_b32 v226, v151, v147, s58
  v_perm_b32 v227, v159, v155, s58
  v_mfma_f32_16x16x32_bf16 v[212:215], v[8:11], v[228:231], 0
  v_perm_b32 v228, v135, v131, s59
  v_perm_b32 v229, v143, v139, s59
  v_perm_b32 v230, v151, v147, s59
  v_perm_b32 v231, v159, v155, s59
  v_mfma_f32_16x16x32_bf16 v[216:219], v[8:11], v[224:227], 0
  s_nop 1
  v_mfma_f32_16x16x32_bf16 v[220:223], v[8:11], v[228:231], 0
  v_sub_f32 v44, 1.0, v44
  v_sub_f32 v45, 1.0, v45
  v_sub_f32 v46, 1.0, v46
  v_sub_f32 v47, 1.0, v47
  s_nop 7
  v_pk_mul_f32 v[192:193], v[192:193], v[44:45]
  v_pk_mul_f32 v[194:195], v[194:195], v[46:47]
  v_pk_mul_f32 v[196:197], v[196:197], v[44:45]
  v_pk_mul_f32 v[198:199], v[198:199], v[46:47]
  v_pk_mul_f32 v[200:201], v[200:201], v[44:45]
  v_pk_mul_f32 v[202:203], v[202:203], v[46:47]
  v_pk_mul_f32 v[204:205], v[204:205], v[44:45]
  v_pk_mul_f32 v[206:207], v[206:207], v[46:47]
  v_pk_mul_f32 v[208:209], v[208:209], v[44:45]
  v_pk_mul_f32 v[210:211], v[210:211], v[46:47]
  v_pk_mul_f32 v[212:213], v[212:213], v[44:45]
  v_pk_mul_f32 v[214:215], v[214:215], v[46:47]
  v_pk_mul_f32 v[216:217], v[216:217], v[44:45]
  v_pk_mul_f32 v[218:219], v[218:219], v[46:47]
  v_pk_mul_f32 v[220:221], v[220:221], v[44:45]
  v_pk_mul_f32 v[222:223], v[222:223], v[46:47]
  s_branch L_soft
L_end:
  s_endpgm
.section .rodata,"a"
.p2align 6
.amdhsa_kernel gated_mix__mha_block_cached__geglu_ffn__decode_kernel
  .amdhsa_next_free_vgpr 256
  .amdhsa_next_free_sgpr 102
  .amdhsa_accum_offset 256
  .amdhsa_group_segment_fixed_size 0
  .amdhsa_kernarg_size 104
  .amdhsa_user_sgpr_count 2
  .amdhsa_user_sgpr_kernarg_segment_ptr 1
  .amdhsa_system_sgpr_workgroup_id_x 1
.end_amdhsa_kernel
```
